```python
import torch

def _softmax(x, axis=-1):
    return torch.softmax(x, dim=axis)
def _gelu(x):
    return torch.nn.functional.gelu(x, approximate="tanh")
def _silu(x):
    return torch.nn.functional.silu(x)
def _sigmoid(x):
    return torch.sigmoid(x)
def _layernorm(x, axis=-1, eps=1e-5):
    m = x.mean(dim=axis, keepdim=True)
    v = x.var(dim=axis, keepdim=True, unbiased=False)
    return (x - m) / torch.sqrt(v + eps)
def _scatter_add(tgt, idx, src, axis=0):
    return tgt.clone().index_add_(axis, idx, src)
def _segment_sum(src, seg, n):
    out = torch.zeros((n,) + src.shape[1:], dtype=src.dtype)
    return out.index_add_(0, seg, src)
def _pad(x, pw):
    flat = tuple(v for pair in reversed(pw) for v in pair)
    return torch.nn.functional.pad(x, flat)

kernel_name = 'recurrent_scan__compressed_kv_cla__geglu_ffn__decode'

def setup_inputs():

    _w = (lambda a: (lambda t: t.to(torch.bfloat16) if t.is_floating_point() else t)(torch.as_tensor(a)))
    def _A_setup():
        B, H, Sq, Sk, D, M = 1, 32, 1, 8192, 128, 640
        Dc = 4 * D
        return {
            "x": _w((lambda *s: torch.randn(*s, dtype=torch.bfloat16) * 0.05)(B, Sq, M)),
            "c_kv": _w((lambda *s: torch.randn(*s, dtype=torch.bfloat16) * 0.8)(B, Sk, Dc)),
            "w_q": _w((lambda *s: torch.randn(*s, dtype=torch.bfloat16) * 1.6)(M, H, D) * (M ** -0.5)),
            "w_uk": _w((lambda *s: torch.randn(*s, dtype=torch.bfloat16) * 1.6)(Dc, H, D) * (Dc ** -0.5)),
            "w_uv": _w((lambda *s: torch.randn(*s, dtype=torch.bfloat16) * 0.8)(Dc, H, D) * (Dc ** -0.5)),
            "w_o": _w((lambda *s: torch.randn(*s, dtype=torch.bfloat16) * 0.8)(H, D, M) * ((H * D) ** -0.5)),
        }
    _A_in = _A_setup()

    def _B_setup():
        B, S, D, F = 1, 1, 640, 1728
        return {
            "x": _w((lambda *s: torch.randn(*s, dtype=torch.bfloat16) * 0.05)(B, S, D)),
            "w_gate": _w((lambda *s: torch.randn(*s, dtype=torch.bfloat16) * 0.2)(D, F)),
            "w_up": _w((lambda *s: torch.randn(*s, dtype=torch.bfloat16) * 0.2)(D, F)),
            "w_down": _w((lambda *s: torch.randn(*s, dtype=torch.bfloat16) * 0.2)(F, D)),
        }
    _B_in = _B_setup()

    return {
        "A_x": _A_in["x"],
        "A_c_kv": _A_in["c_kv"],
        "A_w_q": _A_in["w_q"],
        "A_w_uk": _A_in["w_uk"],
        "A_w_uv": _A_in["w_uv"],
        "A_w_o": _A_in["w_o"],
        "B_x": _B_in["x"],
        "B_w_gate": _B_in["w_gate"],
        "B_w_up": _B_in["w_up"],
        "B_w_down": _B_in["w_down"],
    }

def reference(A_x, A_c_kv, A_w_q, A_w_uk, A_w_uv, A_w_o, B_x, B_w_gate, B_w_up, B_w_down):
    def _A_ref(x, c_kv, w_q, w_uk, w_uv, w_o):
        B, Sq, M = x.shape[0], x.shape[1], x.shape[2]
        Sk = c_kv.shape[1]
        H, D = w_q.shape[1], w_q.shape[2]
        q = torch.einsum("bqm,mhd->bhqd", x, w_q)
        k = torch.einsum("bkc,chd->bhkd", c_kv, w_uk)
        v = torch.einsum("bkc,chd->bhkd", c_kv, w_uv)
        scores = torch.einsum("bhqd,bhkd->bhqk", q, k) * (D ** -0.5)
        off = Sk - Sq
        qi = torch.arange(Sq)[:, None]
        kj = torch.arange(Sk)[None, :]
        cmask = kj <= (qi + off)
        scores = torch.where(cmask[None, None], scores, -1e9)
        p = _softmax(scores, axis=-1)
        ctx = torch.einsum("bhqk,bhkd->bhqd", p, v)
        return torch.einsum("bhqd,hdm->bqm", ctx, w_o)

    def _B_ref(x, w_gate, w_up, w_down):
        return (_gelu(x @ w_gate) * (x @ w_up)) @ w_down

    x = A_x
    xn = _layernorm(x, axis=-1)
    s = _A_ref(xn, A_c_kv, A_w_q, A_w_uk, A_w_uv, A_w_o)
    g = _silu(_B_ref(xn, B_w_gate, B_w_up, B_w_down))
    return x + s * g
```

```asm
; @launch grid=(256,1,1) block=(512,1,1) lds=163840
.amdgcn_target "amdgcn-amd-amdhsa--gfx950"
.text
.globl recurrent_scan__compressed_kv_cla__geglu_ffn__decode_kernel
.p2align 8
.type recurrent_scan__compressed_kv_cla__geglu_ffn__decode_kernel,@function
recurrent_scan__compressed_kv_cla__geglu_ffn__decode_kernel:
    s_cmp_ge_u32 s2, 256
    s_cbranch_scc1 L_end
    s_load_dwordx2 s[40:41], s[0:1], 16
    s_load_dwordx2 s[32:33], s[0:1], 0
    s_load_dwordx2 s[28:29], s[0:1], 96
    s_load_dwordx2 s[36:37], s[0:1], 8
    s_load_dwordx2 s[44:45], s[0:1], 24
    s_getpc_b64 s[4:5]
    s_and_b32 s4, s4, 0xffffff00
    s_lshr_b32 s67, s2, 3
    s_lshr_b32 s68, s67, 4
    s_and_b32 s67, s67, 15
    s_lshl_b32 s6, s67, 11
    v_lshl_add_u32 v5, v0, 2, s6
    v_min_u32 v5, L_code_end-recurrent_scan__compressed_kv_cla__geglu_ffn__decode_kernel-4, v5
    global_load_dword v255, v5, s[4:5]
    v_lshrrev_b32 v7, 6, v0
    v_and_b32 v1, 63, v0
    v_readfirstlane_b32 s64, v7
    s_mov_b32 s3, 0x20000
    s_mov_b32 s42, 5242880
    s_mov_b32 s43, s3
    s_mov_b32 s34, 1280
    s_mov_b32 s35, s3
    s_mov_b32 s30, 16777216
    s_mov_b32 s31, s3
    s_mov_b32 s38, 8388608
    s_mov_b32 s39, s3
    s_mov_b32 s46, 4194304
    s_mov_b32 s47, s3
    s_and_b32 s66, s2, 7
    s_lshr_b32 s6, s67, 2
    s_lshl_b32 s69, s66, 2
    s_add_u32 s69, s69, s6
    s_and_b32 s65, s64, 3
    v_mov_b32 v2, 0
    v_lshlrev_b32 v8, 2, v1
    ds_write_b32 v8, v2 offset:0
    v_and_b32 v15, 15, v1
    v_lshrrev_b32 v14, 4, v1
    v_lshlrev_b32 v11, 4, v1
    s_cmp_lt_u32 s64, 4
    s_cbranch_scc1 L_Y
    s_cmp_eq_u32 s68, 0
    s_cbranch_scc1 L_WX0
    s_lshr_b32 s7, s67, 1
    s_lshl_b32 s72, s66, 3
    s_add_u32 s72, s72, s7
    s_lshl_b32 s8, s72, 2
    s_add_u32 s8, s8, s65
    s_lshl_b32 s8, s8, 15
    s_mul_i32 s9, s65, 33792
    s_add_u32 s9, s9, 28672
    s_mov_b32 m0, s9
    s_add_u32 s10, s8, 32768
    s_waitcnt lgkmcnt(0)
    s_load_dword s70, s[28:29], 0
    s_barrier
L_ckv:
    s_waitcnt vmcnt(7)
    buffer_load_dwordx4 v11, s[36:39], s8 offen nt lds
    s_add_u32 s8, s8, 1024
    s_add_u32 m0, m0, 1056
    s_cmp_lt_u32 s8, s10
    s_cbranch_scc1 L_ckv
    s_branch L_CX
L_WX0:
    s_and_b32 s7, s67, 3
    s_lshl_b32 s8, s7, 2
    s_add_u32 s8, s8, s65
    s_lshl_b32 s8, s8, 18
    s_lshl_b32 s9, s69, 8
    s_add_u32 s8, s8, s9
    s_lshl_b32 s9, s65, 13
    s_add_u32 s9, s9, 28672
    s_mov_b32 m0, s9
    v_lshrrev_b32 v12, 5, v1
    v_xor_b32 v12, v12, v15
    v_lshlrev_b32 v12, 4, v12
    v_lshl_add_u32 v7, v14, 13, v12
    s_mov_b32 s10, 0
    s_waitcnt lgkmcnt(0)
    s_load_dword s70, s[28:29], 0
    s_barrier
L_wuk:
    v_xor_b32 v12, s10, v7
    s_add_u32 s10, s10, 32
    buffer_load_dwordx4 v12, s[44:47], s8 offen nt lds
    s_add_u32 s8, s8, 32768
    s_add_u32 m0, m0, 1024
    s_cmp_lt_u32 s10, 256
    s_cbranch_scc1 L_wuk
    s_branch L_WX
L_Y:
    s_and_b32 s7, s67, 3
    s_lshl_b32 s8, s68, 2
    s_add_u32 s7, s7, s8
    s_lshl_b32 s7, s7, 1
    s_add_u32 s7, s7, s65
    s_mul_i32 s8, s7, 327680
    s_lshl_b32 s9, s69, 8
    s_add_u32 s8, s8, s9
    v_mul_u32_u24 v10, 81920, v14
    v_lshl_add_u32 v10, v15, 4, v10
    s_cmp_ge_u32 s65, 2
    s_waitcnt lgkmcnt(0)
    buffer_load_dwordx4 v[140:143], v11, s[32:35], 0 offen
    buffer_load_dword v144, v8, s[32:35], 0 offen offset:1024
    s_load_dword s70, s[28:29], 0
    s_cbranch_scc1 L_noq
    buffer_load_dwordx4 v[16:19], v10, s[40:43], s8 offen nt
    s_add_u32 s8, s8, 8192
    buffer_load_dwordx4 v[20:23], v10, s[40:43], s8 offen nt
    s_add_u32 s8, s8, 8192
    buffer_load_dwordx4 v[24:27], v10, s[40:43], s8 offen nt
    s_add_u32 s8, s8, 8192
    buffer_load_dwordx4 v[28:31], v10, s[40:43], s8 offen nt
    s_add_u32 s8, s8, 8192
    buffer_load_dwordx4 v[32:35], v10, s[40:43], s8 offen nt
    s_add_u32 s8, s8, 8192
    buffer_load_dwordx4 v[36:39], v10, s[40:43], s8 offen nt
    s_add_u32 s8, s8, 8192
    buffer_load_dwordx4 v[40:43], v10, s[40:43], s8 offen nt
    s_add_u32 s8, s8, 8192
    buffer_load_dwordx4 v[44:47], v10, s[40:43], s8 offen nt
    s_add_u32 s8, s8, 8192
    buffer_load_dwordx4 v[48:51], v10, s[40:43], s8 offen nt
    s_add_u32 s8, s8, 8192
    buffer_load_dwordx4 v[52:55], v10, s[40:43], s8 offen nt
    s_barrier
    s_mov_b32 s71, 262144
    v_mov_b32 v3, 1
    s_lshl_b32 s6, s65, 2
    v_mov_b32 v4, s6
    s_mov_b32 s20, 0x05040100
    s_mov_b32 s21, 0x07060302
    s_waitcnt vmcnt(10)
    s_branch L_ln
L_noq:
    s_barrier
    s_mov_b32 s71, 262144
    v_mov_b32 v3, 1
    s_lshl_b32 s6, s65, 2
    v_mov_b32 v4, s6
    s_mov_b32 s20, 0x05040100
    s_mov_b32 s21, 0x07060302
    s_waitcnt vmcnt(0)
L_ln:
    v_lshlrev_b32 v148, 16, v140
    v_and_b32 v149, 0xffff0000, v140
    v_lshlrev_b32 v150, 16, v141
    v_and_b32 v151, 0xffff0000, v141
    v_lshlrev_b32 v152, 16, v142
    v_and_b32 v153, 0xffff0000, v142
    v_lshlrev_b32 v154, 16, v143
    v_and_b32 v155, 0xffff0000, v143
    v_lshlrev_b32 v156, 16, v144
    v_and_b32 v157, 0xffff0000, v144
    v_add_f32 v160, v148, v149
    v_add_f32 v160, v160, v150
    v_add_f32 v160, v160, v151
    v_add_f32 v160, v160, v152
    v_add_f32 v160, v160, v153
    v_add_f32 v160, v160, v154
    v_add_f32 v160, v160, v155
    v_add_f32 v160, v160, v156
    v_add_f32 v160, v160, v157
    s_nop 1
    v_add_f32_dpp v160, v160, v160 row_ror:8 row_mask:0xf bank_mask:0xf
    s_nop 1
    v_add_f32_dpp v160, v160, v160 row_ror:4 row_mask:0xf bank_mask:0xf
    s_nop 1
    v_add_f32_dpp v160, v160, v160 row_ror:2 row_mask:0xf bank_mask:0xf
    s_nop 1
    v_add_f32_dpp v160, v160, v160 row_ror:1 row_mask:0xf bank_mask:0xf
    v_mov_b32 v161, v160
    s_nop 1
    v_permlane16_swap_b32 v161, v160
    v_add_f32 v160, v160, v161
    v_mov_b32 v161, v160
    s_nop 1
    v_permlane32_swap_b32 v161, v160
    v_add_f32 v160, v160, v161
    v_mul_f32 v160, 0x3acccccd, v160
    v_sub_f32 v162, v148, v160
    v_mul_f32 v163, v162, v162
    v_sub_f32 v162, v149, v160
    v_fmac_f32 v163, v162, v162
    v_sub_f32 v162, v150, v160
    v_fmac_f32 v163, v162, v162
    v_sub_f32 v162, v151, v160
    v_fmac_f32 v163, v162, v162
    v_sub_f32 v162, v152, v160
    v_fmac_f32 v163, v162, v162
    v_sub_f32 v162, v153, v160
    v_fmac_f32 v163, v162, v162
    v_sub_f32 v162, v154, v160
    v_fmac_f32 v163, v162, v162
    v_sub_f32 v162, v155, v160
    v_fmac_f32 v163, v162, v162
    v_sub_f32 v162, v156, v160
    v_fmac_f32 v163, v162, v162
    v_sub_f32 v162, v157, v160
    v_fmac_f32 v163, v162, v162
    s_nop 1
    v_add_f32_dpp v163, v163, v163 row_ror:8 row_mask:0xf bank_mask:0xf
    s_nop 1
    v_add_f32_dpp v163, v163, v163 row_ror:4 row_mask:0xf bank_mask:0xf
    s_nop 1
    v_add_f32_dpp v163, v163, v163 row_ror:2 row_mask:0xf bank_mask:0xf
    s_nop 1
    v_add_f32_dpp v163, v163, v163 row_ror:1 row_mask:0xf bank_mask:0xf
    v_mov_b32 v161, v163
    s_nop 1
    v_permlane16_swap_b32 v161, v163
    v_add_f32 v163, v163, v161
    v_mov_b32 v161, v163
    s_nop 1
    v_permlane32_swap_b32 v161, v163
    v_add_f32 v163, v163, v161
    v_mul_f32 v163, 0x3acccccd, v163
    v_cvt_pk_bf16_f32 v163, v163, v163
    v_and_b32 v163, 0xffff0000, v163
    v_add_f32 v163, 0x3727c5ac, v163
    v_cvt_pk_bf16_f32 v163, v163, v163
    v_and_b32 v163, 0xffff0000, v163
    v_sqrt_f32 v163, v163
    s_nop 0
    v_cvt_pk_bf16_f32 v163, v163, v163
    v_and_b32 v163, 0xffff0000, v163
    v_rcp_f32 v163, v163
    v_cvt_pk_bf16_f32 v160, v160, v160
    v_and_b32 v160, 0xffff0000, v160
    v_sub_f32 v148, v148, v160
    v_sub_f32 v149, v149, v160
    v_cvt_pk_bf16_f32 v162, v148, v149
    v_lshlrev_b32 v148, 16, v162
    v_and_b32 v149, 0xffff0000, v162
    v_mul_f32 v148, v148, v163
    v_mul_f32 v149, v149, v163
    v_cvt_pk_bf16_f32 v140, v148, v149
    v_sub_f32 v150, v150, v160
    v_sub_f32 v151, v151, v160
    v_cvt_pk_bf16_f32 v162, v150, v151
    v_lshlrev_b32 v150, 16, v162
    v_and_b32 v151, 0xffff0000, v162
    v_mul_f32 v150, v150, v163
    v_mul_f32 v151, v151, v163
    v_cvt_pk_bf16_f32 v141, v150, v151
    v_sub_f32 v152, v152, v160
    v_sub_f32 v153, v153, v160
    v_cvt_pk_bf16_f32 v162, v152, v153
    v_lshlrev_b32 v152, 16, v162
    v_and_b32 v153, 0xffff0000, v162
    v_mul_f32 v152, v152, v163
    v_mul_f32 v153, v153, v163
    v_cvt_pk_bf16_f32 v142, v152, v153
    v_sub_f32 v154, v154, v160
    v_sub_f32 v155, v155, v160
    v_cvt_pk_bf16_f32 v162, v154, v155
    v_lshlrev_b32 v154, 16, v162
    v_and_b32 v155, 0xffff0000, v162
    v_mul_f32 v154, v154, v163
    v_mul_f32 v155, v155, v163
    v_cvt_pk_bf16_f32 v143, v154, v155
    v_sub_f32 v156, v156, v160
    v_sub_f32 v157, v157, v160
    v_cvt_pk_bf16_f32 v162, v156, v157
    v_lshlrev_b32 v156, 16, v162
    v_and_b32 v157, 0xffff0000, v162
    v_mul_f32 v156, v156, v163
    v_mul_f32 v157, v157, v163
    v_cvt_pk_bf16_f32 v144, v156, v157
    ds_write_b128 v11, v[140:143] offset:256
    s_waitcnt lgkmcnt(0)
    s_mul_i32 s70, s70, 0x9E3779B1
    s_add_u32 s70, s70, 0x7F4A7C15
    ds_write_b32 v8, v144 offset:1280
    s_cmp_ge_u32 s65, 2
    s_cbranch_scc1 L_aq_done
    s_mul_i32 s11, s7, 80
    v_mul_u32_u24 v12, 20, v14
    v_add_u32 v12, s11, v12
    ds_read_b32 v96, v12 offset:256
    ds_read_b32 v97, v12 offset:260
    ds_read_b32 v98, v12 offset:264
    ds_read_b32 v99, v12 offset:268
    ds_read_b32 v100, v12 offset:272
    s_lshl_b32 s11, s69, 4
    s_add_u32 s11, s11, s7
    s_lshl_b32 s11, s11, 9
    s_add_u32 s12, s11, 327680
    s_add_u32 s11, s11, 65536
    v_lshrrev_b32 v13, 5, v1
    v_lshlrev_b32 v13, 4, v13
    v_lshl_add_u32 v13, v15, 5, v13
    v_mov_b32 v126, 0
    v_mov_b32 v127, s70
    s_waitcnt lgkmcnt(0)
    v_mov_b32 v106, 0
    v_mov_b32 v107, 0
    v_mov_b32 v108, 0
    v_mov_b32 v109, 0
    v_mov_b32 v110, 0
    v_mov_b32 v111, 0
    v_mov_b32 v112, 0
    v_mov_b32 v113, 0
    s_waitcnt vmcnt(8)
    v_perm_b32 v114, v20, v16, s20
    v_perm_b32 v115, v20, v16, s21
    v_perm_b32 v116, v21, v17, s20
    v_perm_b32 v117, v21, v17, s21
    v_perm_b32 v118, v22, v18, s20
    v_perm_b32 v119, v22, v18, s21
    v_perm_b32 v120, v23, v19, s20
    v_perm_b32 v121, v23, v19, s21
    v_dot2c_f32_bf16 v106, v96, v114
    v_dot2c_f32_bf16 v107, v96, v115
    v_dot2c_f32_bf16 v108, v96, v116
    v_dot2c_f32_bf16 v109, v96, v117
    v_dot2c_f32_bf16 v110, v96, v118
    v_dot2c_f32_bf16 v111, v96, v119
    v_dot2c_f32_bf16 v112, v96, v120
    v_dot2c_f32_bf16 v113, v96, v121
    s_waitcnt vmcnt(6)
    v_perm_b32 v114, v28, v24, s20
    v_perm_b32 v115, v28, v24, s21
    v_perm_b32 v116, v29, v25, s20
    v_perm_b32 v117, v29, v25, s21
    v_perm_b32 v118, v30, v26, s20
    v_perm_b32 v119, v30, v26, s21
    v_perm_b32 v120, v31, v27, s20
    v_perm_b32 v121, v31, v27, s21
    v_dot2c_f32_bf16 v106, v97, v114
    v_dot2c_f32_bf16 v107, v97, v115
    v_dot2c_f32_bf16 v108, v97, v116
    v_dot2c_f32_bf16 v109, v97, v117
    v_dot2c_f32_bf16 v110, v97, v118
    v_dot2c_f32_bf16 v111, v97, v119
    v_dot2c_f32_bf16 v112, v97, v120
    v_dot2c_f32_bf16 v113, v97, v121
    s_waitcnt vmcnt(4)
    v_perm_b32 v114, v36, v32, s20
    v_perm_b32 v115, v36, v32, s21
    v_perm_b32 v116, v37, v33, s20
    v_perm_b32 v117, v37, v33, s21
    v_perm_b32 v118, v38, v34, s20
    v_perm_b32 v119, v38, v34, s21
    v_perm_b32 v120, v39, v35, s20
    v_perm_b32 v121, v39, v35, s21
    v_dot2c_f32_bf16 v106, v98, v114
    v_dot2c_f32_bf16 v107, v98, v115
    v_dot2c_f32_bf16 v108, v98, v116
    v_dot2c_f32_bf16 v109, v98, v117
    v_dot2c_f32_bf16 v110, v98, v118
    v_dot2c_f32_bf16 v111, v98, v119
    v_dot2c_f32_bf16 v112, v98, v120
    v_dot2c_f32_bf16 v113, v98, v121
    s_waitcnt vmcnt(2)
    v_perm_b32 v114, v44, v40, s20
    v_perm_b32 v115, v44, v40, s21
    v_perm_b32 v116, v45, v41, s20
    v_perm_b32 v117, v45, v41, s21
    v_perm_b32 v118, v46, v42, s20
    v_perm_b32 v119, v46, v42, s21
    v_perm_b32 v120, v47, v43, s20
    v_perm_b32 v121, v47, v43, s21
    v_dot2c_f32_bf16 v106, v99, v114
    v_dot2c_f32_bf16 v107, v99, v115
    v_dot2c_f32_bf16 v108, v99, v116
    v_dot2c_f32_bf16 v109, v99, v117
    v_dot2c_f32_bf16 v110, v99, v118
    v_dot2c_f32_bf16 v111, v99, v119
    v_dot2c_f32_bf16 v112, v99, v120
    v_dot2c_f32_bf16 v113, v99, v121
    s_waitcnt vmcnt(0)
    v_perm_b32 v114, v52, v48, s20
    v_perm_b32 v115, v52, v48, s21
    v_perm_b32 v116, v53, v49, s20
    v_perm_b32 v117, v53, v49, s21
    v_perm_b32 v118, v54, v50, s20
    v_perm_b32 v119, v54, v50, s21
    v_perm_b32 v120, v55, v51, s20
    v_perm_b32 v121, v55, v51, s21
    v_dot2c_f32_bf16 v106, v100, v114
    v_dot2c_f32_bf16 v107, v100, v115
    v_dot2c_f32_bf16 v108, v100, v116
    v_dot2c_f32_bf16 v109, v100, v117
    v_dot2c_f32_bf16 v110, v100, v118
    v_dot2c_f32_bf16 v111, v100, v119
    v_dot2c_f32_bf16 v112, v100, v120
    v_dot2c_f32_bf16 v113, v100, v121
    v_permlane32_swap_b32 v106, v110
    v_permlane32_swap_b32 v107, v111
    v_permlane32_swap_b32 v108, v112
    v_permlane32_swap_b32 v109, v113
    v_add_f32 v106, v106, v110
    v_add_f32 v107, v107, v111
    v_add_f32 v108, v108, v112
    v_add_f32 v109, v109, v113
    s_nop 0
    v_permlane16_swap_b32 v106, v108
    v_permlane16_swap_b32 v107, v109
    v_add_f32 v106, v106, v108
    v_add_f32 v107, v107, v109
    v_cvt_pk_bf16_f32 v125, v106, v107
    v_mov_b32 v124, v125
    s_nop 1
    v_permlane16_swap_b32 v124, v125
    s_mov_b32 exec_lo, 0xffff
    s_mov_b32 exec_hi, 0xffff
    buffer_store_dwordx4 v[124:127], v13, s[28:31], s11 offen
    buffer_store_dwordx4 v[124:127], v13, s[28:31], s12 offen sc1
    s_mov_b64 exec, 1
    ds_write_b32 v4, v3 offset:0
    s_mov_b64 exec, -1
L_aq_done:
    s_load_dwordx2 s[48:49], s[0:1], 32
    s_load_dwordx2 s[52:53], s[0:1], 40
    s_load_dwordx2 s[56:57], s[0:1], 56
    s_load_dwordx2 s[22:23], s[0:1], 64
    s_load_dwordx2 s[60:61], s[0:1], 72
    s_mov_b32 s50, 4194304
    s_mov_b32 s51, s3
    s_mov_b32 s54, 5242880
    s_mov_b32 s55, s3
    s_mov_b32 s58, 2211840
    s_mov_b32 s59, s3
    s_mov_b32 s62, 2211840
    s_mov_b32 s63, s3
    s_lshl_b32 s17, s65, 8
    v_lshl_add_u32 v13, v15, 4, s17
    s_lshl_b32 s17, s65, 6
    s_add_u32 s17, s17, 1024
    v_lshl_add_u32 v8, v15, 2, s17
    v_lshlrev_b32 v5, 4, v14
    v_lshl_add_u32 v5, v15, 6, v5
    s_lshl_b32 s19, s67, 3
    s_add_u32 s19, s19, s66
    s_lshl_b32 s19, s19, 2
    s_add_u32 s19, s19, s65
    s_lshl_b32 s19, s19, 10
    s_cmp_eq_u32 s68, 1
    s_cbranch_scc1 L_CY
    v_mul_u32_u24 v11, 10240, v14
    v_add_u32 v9, v11, v8
    v_add_u32 v11, v11, v13
    v_lshlrev_b32 v10, 18, v14
    v_lshl_add_u32 v10, v15, 3, v10
    s_and_b32 s7, s67, 1
    s_lshl_b32 s7, s7, 7
    s_lshl_b32 s8, s69, 8
    s_add_u32 s7, s7, s8
    s_bfe_u32 s17, s67, 0x10001
    s_lshl_b32 s17, s17, 6
    s_add_u32 s17, s17, s65
    s_lshl_b32 s17, s17, 15
    s_add_u32 s17, s17, s7
    s_mul_i32 s18, s7, 640
    v_mul_u32_u24 v6, 656, v15
    v_lshl_add_u32 v6, v14, 4, v6
    s_mul_i32 s14, s65, 80
    v_add_u32 v6, s14, v6
    v_and_b32 v8, 3, v1
    v_mul_u32_u24 v7, 144, v8
    v_lshl_add_u32 v7, v14, 4, v7
    v_lshlrev_b32 v12, 1, v14
    v_lshl_add_u32 v12, v15, 3, v12
    s_mul_i32 s14, s65, 144
    v_add_u32 v12, s14, v12
    s_add_u32 s19, s19, 5242880
L_fw_1:
    ds_read_b128 v[200:203], v2 offset:32
    s_waitcnt lgkmcnt(0)
    v_min3_u32 v200, v200, v201, v202
    v_min_u32 v200, v200, v203
    v_cmp_eq_u32 vcc, 0, v200
    s_cbranch_vccz L_fd_2
    s_sleep 1
    s_sub_u32 s71, s71, 1
    s_cmp_gt_i32 s71, 0
    s_cbranch_scc1 L_fw_1
L_fd_2:
    buffer_load_dwordx2 v[136:137], v10, s[48:51], s17 offen nt
    s_add_u32 s17, s17, 8192
    buffer_load_dwordx2 v[138:139], v10, s[48:51], s17 offen nt
    s_add_u32 s17, s17, 8192
    buffer_load_dwordx2 v[140:141], v10, s[48:51], s17 offen nt
    s_add_u32 s17, s17, 8192
    buffer_load_dwordx2 v[142:143], v10, s[48:51], s17 offen nt
    s_add_u32 s17, s17, 106496
    buffer_load_dwordx2 v[144:145], v10, s[48:51], s17 offen nt
    s_add_u32 s17, s17, 8192
    buffer_load_dwordx2 v[146:147], v10, s[48:51], s17 offen nt
    s_add_u32 s17, s17, 8192
    buffer_load_dwordx2 v[148:149], v10, s[48:51], s17 offen nt
    s_add_u32 s17, s17, 8192
    buffer_load_dwordx2 v[150:151], v10, s[48:51], s17 offen nt
    s_add_u32 s17, s17, 892928
    buffer_load_dwordx2 v[152:153], v10, s[48:51], s17 offen nt
    s_add_u32 s17, s17, 8192
    buffer_load_dwordx2 v[154:155], v10, s[48:51], s17 offen nt
    s_add_u32 s17, s17, 8192
    buffer_load_dwordx2 v[156:157], v10, s[48:51], s17 offen nt
    s_add_u32 s17, s17, 8192
    buffer_load_dwordx2 v[158:159], v10, s[48:51], s17 offen nt
    s_add_u32 s17, s17, 106496
    buffer_load_dwordx2 v[160:161], v10, s[48:51], s17 offen nt
    s_add_u32 s17, s17, 8192
    buffer_load_dwordx2 v[162:163], v10, s[48:51], s17 offen nt
    s_add_u32 s17, s17, 8192
    buffer_load_dwordx2 v[164:165], v10, s[48:51], s17 offen nt
    s_add_u32 s17, s17, 8192
    buffer_load_dwordx2 v[166:167], v10, s[48:51], s17 offen nt
    buffer_load_dwordx4 v[16:19], v11, s[52:55], s18 offen offset:0 nt
    buffer_load_dword v48, v9, s[52:55], s18 offen offset:0 nt
    buffer_load_dwordx4 v[20:23], v11, s[52:55], s18 offen offset:1280 nt
    buffer_load_dword v49, v9, s[52:55], s18 offen offset:1280 nt
    s_add_u32 s18, s18, 2560
    s_waitcnt vmcnt(18)
    buffer_load_dwordx4 v[24:27], v11, s[52:55], s18 offen offset:0 nt
    buffer_load_dword v50, v9, s[52:55], s18 offen offset:0 nt
    s_waitcnt vmcnt(18)
    buffer_load_dwordx4 v[28:31], v11, s[52:55], s18 offen offset:1280 nt
    buffer_load_dword v51, v9, s[52:55], s18 offen offset:1280 nt
    s_add_u32 s18, s18, 2560
    s_waitcnt vmcnt(18)
    buffer_load_dwordx4 v[32:35], v11, s[52:55], s18 offen offset:0 nt
    buffer_load_dword v52, v9, s[52:55], s18 offen offset:0 nt
    s_waitcnt vmcnt(18)
    buffer_load_dwordx4 v[36:39], v11, s[52:55], s18 offen offset:1280 nt
    buffer_load_dword v53, v9, s[52:55], s18 offen offset:1280 nt
    s_add_u32 s18, s18, 2560
    v_perm_b32 v168, v138, v136, s20
    v_perm_b32 v169, v142, v140, s20
    v_perm_b32 v170, v146, v144, s20
    v_perm_b32 v171, v150, v148, s20
    v_perm_b32 v172, v138, v136, s21
    v_perm_b32 v173, v142, v140, s21
    v_perm_b32 v174, v146, v144, s21
    v_perm_b32 v175, v150, v148, s21
    v_perm_b32 v176, v139, v137, s20
    v_perm_b32 v177, v143, v141, s20
    v_perm_b32 v178, v147, v145, s20
    v_perm_b32 v179, v151, v149, s20
    v_perm_b32 v180, v139, v137, s21
    v_perm_b32 v181, v143, v141, s21
    v_perm_b32 v182, v147, v145, s21
    v_perm_b32 v183, v151, v149, s21
    s_waitcnt vmcnt(18)
    buffer_load_dwordx4 v[40:43], v11, s[52:55], s18 offen offset:0 nt
    buffer_load_dword v54, v9, s[52:55], s18 offen offset:0 nt
    s_waitcnt vmcnt(18)
    buffer_load_dwordx4 v[44:47], v11, s[52:55], s18 offen offset:1280 nt
    buffer_load_dword v55, v9, s[52:55], s18 offen offset:1280 nt
    s_add_u32 s18, s18, 33280
    s_waitcnt vmcnt(18)
    buffer_load_dwordx4 v[56:59], v11, s[52:55], s18 offen offset:0 nt
    buffer_load_dword v88, v9, s[52:55], s18 offen offset:0 nt
    s_waitcnt vmcnt(18)
    buffer_load_dwordx4 v[60:63], v11, s[52:55], s18 offen offset:1280 nt
    buffer_load_dword v89, v9, s[52:55], s18 offen offset:1280 nt
    s_add_u32 s18, s18, 2560
    v_perm_b32 v184, v154, v152, s20
    v_perm_b32 v185, v158, v156, s20
    v_perm_b32 v186, v162, v160, s20
    v_perm_b32 v187, v166, v164, s20
    v_perm_b32 v188, v154, v152, s21
    v_perm_b32 v189, v158, v156, s21
    v_perm_b32 v190, v162, v160, s21
    v_perm_b32 v191, v166, v164, s21
    v_perm_b32 v192, v155, v153, s20
    v_perm_b32 v193, v159, v157, s20
    v_perm_b32 v194, v163, v161, s20
    v_perm_b32 v195, v167, v165, s20
    v_perm_b32 v196, v155, v153, s21
    v_perm_b32 v197, v159, v157, s21
    v_perm_b32 v198, v163, v161, s21
    v_perm_b32 v199, v167, v165, s21
    s_waitcnt vmcnt(18)
    buffer_load_dwordx4 v[64:67], v11, s[52:55], s18 offen offset:0 nt
    buffer_load_dword v90, v9, s[52:55], s18 offen offset:0 nt
    s_waitcnt vmcnt(18)
    buffer_load_dwordx4 v[68:71], v11, s[52:55], s18 offen offset:1280 nt
    buffer_load_dword v91, v9, s[52:55], s18 offen offset:1280 nt
    s_add_u32 s18, s18, 2560
    v_perm_b32 v96, v20, v16, s20
    v_perm_b32 v100, v20, v16, s21
    v_perm_b32 v104, v21, v17, s20
    v_perm_b32 v108, v21, v17, s21
    v_perm_b32 v112, v22, v18, s20
    v_perm_b32 v116, v22, v18, s21
    v_perm_b32 v120, v23, v19, s20
    v_perm_b32 v124, v23, v19, s21
    v_perm_b32 v128, v49, v48, s20
    v_perm_b32 v132, v49, v48, s21
    s_waitcnt vmcnt(18)
    buffer_load_dwordx4 v[72:75], v11, s[52:55], s18 offen offset:0 nt
    buffer_load_dword v92, v9, s[52:55], s18 offen offset:0 nt
    s_waitcnt vmcnt(18)
    buffer_load_dwordx4 v[76:79], v11, s[52:55], s18 offen offset:1280 nt
    buffer_load_dword v93, v9, s[52:55], s18 offen offset:1280 nt
    s_add_u32 s18, s18, 2560
    v_perm_b32 v97, v28, v24, s20
    v_perm_b32 v101, v28, v24, s21
    v_perm_b32 v105, v29, v25, s20
    v_perm_b32 v109, v29, v25, s21
    v_perm_b32 v113, v30, v26, s20
    v_perm_b32 v117, v30, v26, s21
    v_perm_b32 v121, v31, v27, s20
    v_perm_b32 v125, v31, v27, s21
    v_perm_b32 v129, v51, v50, s20
    v_perm_b32 v133, v51, v50, s21
    s_waitcnt vmcnt(18)
    buffer_load_dwordx4 v[80:83], v11, s[52:55], s18 offen offset:0 nt
    buffer_load_dword v94, v9, s[52:55], s18 offen offset:0 nt
    s_waitcnt vmcnt(18)
    buffer_load_dwordx4 v[84:87], v11, s[52:55], s18 offen offset:1280 nt
    buffer_load_dword v95, v9, s[52:55], s18 offen offset:1280 nt
    v_perm_b32 v98, v36, v32, s20
    v_perm_b32 v102, v36, v32, s21
    v_perm_b32 v106, v37, v33, s20
    v_perm_b32 v110, v37, v33, s21
    v_perm_b32 v114, v38, v34, s20
    v_perm_b32 v118, v38, v34, s21
    v_perm_b32 v122, v39, v35, s20
    v_perm_b32 v126, v39, v35, s21
    v_perm_b32 v130, v53, v52, s20
    v_perm_b32 v134, v53, v52, s21
    s_waitcnt vmcnt(18)
    s_waitcnt vmcnt(16)
    v_perm_b32 v99, v44, v40, s20
    v_perm_b32 v103, v44, v40, s21
    v_perm_b32 v107, v45, v41, s20
    v_perm_b32 v111, v45, v41, s21
    v_perm_b32 v115, v46, v42, s20
    v_perm_b32 v119, v46, v42, s21
    v_perm_b32 v123, v47, v43, s20
    v_perm_b32 v127, v47, v43, s21
    v_perm_b32 v131, v55, v54, s20
    v_perm_b32 v135, v55, v54, s21
    s_waitcnt vmcnt(14)
    s_waitcnt vmcnt(12)
    v_perm_b32 v16, v60, v56, s20
    v_perm_b32 v20, v60, v56, s21
    v_perm_b32 v24, v61, v57, s20
    v_perm_b32 v28, v61, v57, s21
    v_perm_b32 v32, v62, v58, s20
    v_perm_b32 v36, v62, v58, s21
    v_perm_b32 v40, v63, v59, s20
    v_perm_b32 v44, v63, v59, s21
    v_perm_b32 v48, v89, v88, s20
    v_perm_b32 v52, v89, v88, s21
    s_waitcnt vmcnt(10)
    s_waitcnt vmcnt(8)
    v_perm_b32 v17, v68, v64, s20
    v_perm_b32 v21, v68, v64, s21
    v_perm_b32 v25, v69, v65, s20
    v_perm_b32 v29, v69, v65, s21
    v_perm_b32 v33, v70, v66, s20
    v_perm_b32 v37, v70, v66, s21
    v_perm_b32 v41, v71, v67, s20
    v_perm_b32 v45, v71, v67, s21
    v_perm_b32 v49, v91, v90, s20
    v_perm_b32 v53, v91, v90, s21
    s_waitcnt vmcnt(6)
    s_waitcnt vmcnt(4)
    v_perm_b32 v18, v76, v72, s20
    v_perm_b32 v22, v76, v72, s21
    v_perm_b32 v26, v77, v73, s20
    v_perm_b32 v30, v77, v73, s21
    v_perm_b32 v34, v78, v74, s20
    v_perm_b32 v38, v78, v74, s21
    v_perm_b32 v42, v79, v75, s20
    v_perm_b32 v46, v79, v75, s21
    v_perm_b32 v50, v93, v92, s20
    v_perm_b32 v54, v93, v92, s21
    s_waitcnt vmcnt(2)
    s_waitcnt vmcnt(0)
    v_perm_b32 v19, v84, v80, s20
    v_perm_b32 v23, v84, v80, s21
    v_perm_b32 v27, v85, v81, s20
    v_perm_b32 v31, v85, v81, s21
    v_perm_b32 v35, v86, v82, s20
    v_perm_b32 v39, v86, v82, s21
    v_perm_b32 v43, v87, v83, s20
    v_perm_b32 v47, v87, v83, s21
    v_perm_b32 v51, v95, v94, s20
    v_perm_b32 v55, v95, v94, s21
    v_mov_b32 v147, s70
    v_mov_b32 v145, 0
    v_mov_b32 v146, 0
L_fw_3:
    ds_read_b128 v[228:231], v2 offset:144
    s_waitcnt lgkmcnt(0)
    v_cmp_eq_u32 vcc, 0, v228
    s_cbranch_vccz L_fd_4
    s_sleep 2
    s_sub_u32 s71, s71, 1
    s_cmp_gt_i32 s71, 0
    s_cbranch_scc1 L_fw_3
L_fd_4:
L_fw_5:
    ds_read_b128 v[228:231], v2 offset:96
    ds_read_b128 v[216:219], v6 offset:16384
    ds_read_b128 v[220:223], v6 offset:16704
    ds_read_b32 v224, v2 offset:3072
    s_waitcnt lgkmcnt(0)
    v_min3_u32 v228, v228, v229, v230
    v_min_u32 v228, v228, v231
    v_cmp_eq_u32 vcc, 0, v228
    s_cbranch_vccz L_fd_6
    s_sub_u32 s71, s71, 1
    s_cmp_gt_i32 s71, 0
    s_cbranch_scc1 L_fw_5
L_fd_6:
    v_mfma_f32_16x16x32_bf16 v[200:203], v[216:219], v[168:171], 0
    v_mfma_f32_16x16x32_bf16 v[204:207], v[216:219], v[172:175], 0
    v_mfma_f32_16x16x32_bf16 v[208:211], v[216:219], v[176:179], 0
    v_mfma_f32_16x16x32_bf16 v[212:215], v[216:219], v[180:183], 0
    v_mfma_f32_16x16x32_bf16 v[200:203], v[220:223], v[184:187], v[200:203]
    v_mfma_f32_16x16x32_bf16 v[204:207], v[220:223], v[188:191], v[204:207]
    v_mfma_f32_16x16x32_bf16 v[208:211], v[220:223], v[192:195], v[208:211]
    v_mfma_f32_16x16x32_bf16 v[212:215], v[220:223], v[196:199], v[212:215]
    s_nop 4
    v_add_f32 v200, v200, v201
    v_add_f32 v202, v202, v203
    v_add_f32 v200, v200, v202
    v_add_f32 v204, v204, v205
    v_add_f32 v206, v206, v207
    v_add_f32 v204, v204, v206
    v_add_f32 v208, v208, v209
    v_add_f32 v210, v210, v211
    v_add_f32 v208, v208, v210
    v_add_f32 v212, v212, v213
    v_add_f32 v214, v214, v215
    v_add_f32 v212, v212, v214
    v_permlane16_swap_b32 v200, v204
    s_nop 0
    v_permlane16_swap_b32 v208, v212
    v_add_f32 v200, v200, v204
    v_add_f32 v208, v208, v212
    s_nop 1
    v_permlane32_swap_b32 v200, v208
    v_add_f32 v200, v200, v208
    v_mul_f32 v200, v200, v224
    v_cvt_pk_bf16_f32 v200, v200, v200
    ds_write_b16 v12, v200 offset:2368
    s_mov_b64 exec, 1
    ds_write_b32 v4, v3 offset:112
    s_mov_b64 exec, -1
L_fw_7:
    ds_read_b128 v[228:231], v2 offset:112
    ds_read_b128 v[136:139], v7 offset:2368
    ds_read_b128 v[140:143], v7 offset:2432
    s_waitcnt lgkmcnt(0)
    v_min3_u32 v228, v228, v229, v230
    v_min_u32 v228, v228, v231
    v_cmp_eq_u32 vcc, 0, v228
    s_cbranch_vccz L_fd_8
    s_sub_u32 s71, s71, 1
    s_cmp_gt_i32 s71, 0
    s_cbranch_scc1 L_fw_7
L_fd_8:
    v_mfma_f32_16x16x32_bf16 v[56:59], v[136:139], v[96:99], 0
    v_mfma_f32_16x16x32_bf16 v[56:59], v[140:143], v[16:19], v[56:59]
    v_mfma_f32_16x16x32_bf16 v[60:63], v[136:139], v[100:103], 0
    v_mfma_f32_16x16x32_bf16 v[60:63], v[140:143], v[20:23], v[60:63]
    v_mfma_f32_16x16x32_bf16 v[64:67], v[136:139], v[104:107], 0
    v_mfma_f32_16x16x32_bf16 v[64:67], v[140:143], v[24:27], v[64:67]
    s_nop 3
    v_add_f32 v56, v56, v57
    v_add_f32 v58, v58, v59
    s_nop 0
    v_add_f32_dpp v144, v56, v58 quad_perm:[0,1,2,3] row_mask:0x1 bank_mask:0xf
    v_mfma_f32_16x16x32_bf16 v[68:71], v[136:139], v[108:111], 0
    v_mfma_f32_16x16x32_bf16 v[68:71], v[140:143], v[28:31], v[68:71]
    v_add_f32 v60, v60, v61
    v_add_f32 v62, v62, v63
    s_nop 0
    v_add_f32_dpp v145, v60, v62 quad_perm:[0,1,2,3] row_mask:0x1 bank_mask:0xf
    v_mfma_f32_16x16x32_bf16 v[72:75], v[136:139], v[112:115], 0
    v_mfma_f32_16x16x32_bf16 v[72:75], v[140:143], v[32:35], v[72:75]
    v_add_f32 v64, v64, v65
    v_add_f32 v66, v66, v67
    s_nop 0
    v_add_f32_dpp v146, v64, v66 quad_perm:[0,1,2,3] row_mask:0x1 bank_mask:0xf
    v_mfma_f32_16x16x32_bf16 v[76:79], v[136:139], v[116:119], 0
    v_mfma_f32_16x16x32_bf16 v[76:79], v[140:143], v[36:39], v[76:79]
    v_add_f32 v68, v68, v69
    v_add_f32 v70, v70, v71
    s_nop 0
    v_add_f32_dpp v144, v68, v70 quad_perm:[0,1,2,3] row_mask:0x2 bank_mask:0xf
    v_mfma_f32_16x16x32_bf16 v[80:83], v[136:139], v[120:123], 0
    v_mfma_f32_16x16x32_bf16 v[80:83], v[140:143], v[40:43], v[80:83]
    v_add_f32 v72, v72, v73
    v_add_f32 v74, v74, v75
    s_nop 0
    v_add_f32_dpp v145, v72, v74 quad_perm:[0,1,2,3] row_mask:0x2 bank_mask:0xf
    v_mfma_f32_16x16x32_bf16 v[84:87], v[136:139], v[124:127], 0
    v_mfma_f32_16x16x32_bf16 v[84:87], v[140:143], v[44:47], v[84:87]
    v_add_f32 v76, v76, v77
    v_add_f32 v78, v78, v79
    s_nop 0
    v_add_f32_dpp v146, v76, v78 quad_perm:[0,1,2,3] row_mask:0x2 bank_mask:0xf
    v_mfma_f32_16x16x32_bf16 v[88:91], v[136:139], v[128:131], 0
    v_mfma_f32_16x16x32_bf16 v[88:91], v[140:143], v[48:51], v[88:91]
    v_add_f32 v80, v80, v81
    v_add_f32 v82, v82, v83
    s_nop 0
    v_add_f32_dpp v144, v80, v82 quad_perm:[0,1,2,3] row_mask:0x4 bank_mask:0xf
    v_mfma_f32_16x16x32_bf16 v[92:95], v[136:139], v[132:135], 0
    v_mfma_f32_16x16x32_bf16 v[92:95], v[140:143], v[52:55], v[92:95]
    v_add_f32 v84, v84, v85
    v_add_f32 v86, v86, v87
    s_nop 0
    v_add_f32_dpp v145, v84, v86 quad_perm:[0,1,2,3] row_mask:0x4 bank_mask:0xf
    v_add_f32 v88, v88, v89
    v_add_f32 v90, v90, v91
    s_nop 0
    v_add_f32_dpp v146, v88, v90 quad_perm:[0,1,2,3] row_mask:0x4 bank_mask:0xf
    v_add_f32 v92, v92, v93
    v_add_f32 v94, v94, v95
    s_nop 0
    v_add_f32_dpp v144, v92, v94 quad_perm:[0,1,2,3] row_mask:0x8 bank_mask:0xf
    buffer_store_dwordx4 v[144:147], v5, s[28:31], s19 offen sc1
    s_mov_b64 exec, 1
    ds_write_b32 v4, v3 offset:160
    s_mov_b64 exec, -1
    s_branch L_fin
L_CY:
    s_lshr_b32 s13, s67, 2
    s_lshl_b32 s13, s13, 3
    s_add_u32 s13, s13, s66
    s_cmp_lt_u32 s13, 27
    s_cselect_b32 s7, 1, 0
    s_waitcnt lgkmcnt(0)
    s_cmp_ge_u32 s65, 2
    s_cselect_b32 s56, s22, s56
    s_cselect_b32 s57, s23, s57
    s_and_b32 s14, s67, 3
    s_lshl_b32 s15, s14, 1
    s_and_b32 s16, s65, 1
    s_add_u32 s15, s15, s16
    s_mul_i32 s8, s15, 276480
    s_lshl_b32 s16, s13, 7
    s_add_u32 s8, s8, s16
    s_lshl_b32 s16, s13, 2
    s_add_u32 s16, s16, s14
    s_mul_i32 s9, s16, 20480
    s_lshl_b32 s10, s16, 2
    s_add_u32 s10, s10, s65
    s_lshl_b32 s10, s10, 9
    s_add_u32 s4, s10, 4194304
    s_add_u32 s10, s10, 655360
    s_lshl_b32 s11, s13, 13
    s_lshl_b32 s12, s14, 7
    s_add_u32 s11, s11, s12
    s_add_u32 s5, s11, 655360
    s_add_u32 s11, s11, 4194304
    s_add_u32 s19, s19, 6291456
    v_lshrrev_b32 v12, 3, v1
    v_lshlrev_b32 v254, 4, v1
    v_and_b32 v11, 7, v1
    v_mul_u32_u24 v6, 34560, v12
    v_lshl_add_u32 v6, v11, 4, v6
    v_mul_u32_u24 v7, 5120, v14
    v_add_u32 v9, v7, v8
    v_add_u32 v7, v7, v13
    s_mul_i32 s15, s15, 160
    v_mul_u32_u24 v13, 20, v12
    v_add_u32 v13, s15, v13
    ds_read_b32 v240, v13 offset:256
    ds_read_b32 v241, v13 offset:260
    ds_read_b32 v242, v13 offset:264
    ds_read_b32 v243, v13 offset:268
    ds_read_b32 v244, v13 offset:272
    v_lshlrev_b32 v8, 11, v14
    v_and_b32 v12, 1, v12
    v_lshl_add_u32 v8, v12, 9, v8
    v_lshl_add_u32 v10, v11, 4, v8
    v_lshlrev_b32 v252, 4, v14
    v_lshl_add_u32 v252, v11, 6, v252
    v_lshrrev_b32 v13, 2, v15
    v_lshl_add_u32 v13, v14, 2, v13
    v_mul_u32_u24 v12, 1056, v13
    v_and_b32 v13, 3, v1
    v_lshl_add_u32 v12, v13, 3, v12
    s_lshl_b32 s12, s65, 8
    s_add_u32 s12, s12, 28672
    v_add_u32 v12, s12, v12
    v_add_u32 v250, 67584, v12
    v_lshrrev_b32 v13, 1, v15
    v_mul_u32_u24 v251, 196608, v13
    v_and_b32 v13, 1, v1
    v_lshl_add_u32 v251, v13, 6, v251
    v_lshl_add_u32 v251, v14, 4, v251
    s_and_b32 s13, s67, 1
    s_lshl_b32 s13, s13, 5
    s_add_u32 s13, s13, s65
    s_lshl_b32 s13, s13, 3
    s_add_u32 s13, s13, s66
    s_lshl_b32 s13, s13, 3
    s_lshr_b32 s12, s67, 1
    s_add_u32 s13, s13, s12
    s_mul_i32 s13, s13, 768
    s_add_u32 s13, s13, 1048576
    v_lshlrev_b32 v253, 4, v15
    v_mov_b32 v192, 0x3f803f80
    v_mov_b32 v193, 0x3f803f80
    v_mov_b32 v194, 0x3f803f80
    v_mov_b32 v195, 0x3f803f80
    s_lshl_b32 s18, s67, 3
    s_add_u32 s18, s18, s66
    s_lshl_b32 s18, s18, 7
    s_add_u32 s18, s18, 4096
    s_mov_b32 s12, 0
    s_mov_b32 s17, s11
L_fw_9:
    ds_read_b128 v[246:249], v2 offset:128
    s_waitcnt lgkmcnt(0)
    v_min3_u32 v246, v246, v247, v248
    v_min_u32 v246, v246, v249
    v_cmp_eq_u32 vcc, 0, v246
    s_cbranch_vccz L_fd_10
    s_sleep 1
    s_sub_u32 s71, s71, 1
    s_cmp_gt_i32 s71, 0
    s_cbranch_scc1 L_fw_9
L_fd_10:
    s_cmp_eq_u32 s7, 0
    s_cbranch_scc1 L_nf_11
    buffer_load_dwordx4 v[200:203], v6, s[56:59], s8 offen offset:0 nt
    buffer_load_dwordx4 v[204:207], v6, s[56:59], s8 offen offset:3456 nt
    s_add_u32 s8, s8, 6912
    buffer_load_dwordx4 v[208:211], v6, s[56:59], s8 offen offset:0 nt
    buffer_load_dwordx4 v[212:215], v6, s[56:59], s8 offen offset:3456 nt
    s_add_u32 s8, s8, 6912
    buffer_load_dwordx4 v[216:219], v6, s[56:59], s8 offen offset:0 nt
    buffer_load_dwordx4 v[220:223], v6, s[56:59], s8 offen offset:3456 nt
    s_add_u32 s8, s8, 6912
    buffer_load_dwordx4 v[224:227], v6, s[56:59], s8 offen offset:0 nt
    buffer_load_dwordx4 v[228:231], v6, s[56:59], s8 offen offset:3456 nt
    s_add_u32 s8, s8, 6912
    buffer_load_dwordx4 v[232:235], v6, s[56:59], s8 offen offset:0 nt
    buffer_load_dwordx4 v[236:239], v6, s[56:59], s8 offen offset:3456 nt
L_nf_11:
    ds_read_b64_tr_b16 v[16:17], v12 offset:0
    ds_read_b64_tr_b16 v[18:19], v12 offset:16896
    ds_read_b64_tr_b16 v[20:21], v12 offset:33792
    ds_read_b64_tr_b16 v[22:23], v12 offset:50688
    ds_read_b64_tr_b16 v[24:25], v250 offset:0
    ds_read_b64_tr_b16 v[26:27], v250 offset:16896
    ds_read_b64_tr_b16 v[28:29], v250 offset:33792
    ds_read_b64_tr_b16 v[30:31], v250 offset:50688
    ds_read_b64_tr_b16 v[32:33], v12 offset:32
    ds_read_b64_tr_b16 v[34:35], v12 offset:16928
    ds_read_b64_tr_b16 v[36:37], v12 offset:33824
    ds_read_b64_tr_b16 v[38:39], v12 offset:50720
    ds_read_b64_tr_b16 v[40:41], v250 offset:32
    ds_read_b64_tr_b16 v[42:43], v250 offset:16928
    ds_read_b64_tr_b16 v[44:45], v250 offset:33824
    ds_read_b64_tr_b16 v[46:47], v250 offset:50720
    ds_read_b64_tr_b16 v[48:49], v12 offset:64
    ds_read_b64_tr_b16 v[50:51], v12 offset:16960
    ds_read_b64_tr_b16 v[52:53], v12 offset:33856
    ds_read_b64_tr_b16 v[54:55], v12 offset:50752
    ds_read_b64_tr_b16 v[56:57], v250 offset:64
    ds_read_b64_tr_b16 v[58:59], v250 offset:16960
    ds_read_b64_tr_b16 v[60:61], v250 offset:33856
    ds_read_b64_tr_b16 v[62:63], v250 offset:50752
    ds_read_b64_tr_b16 v[64:65], v12 offset:96
    ds_read_b64_tr_b16 v[66:67], v12 offset:16992
    ds_read_b64_tr_b16 v[68:69], v12 offset:33888
    ds_read_b64_tr_b16 v[70:71], v12 offset:50784
    ds_read_b64_tr_b16 v[72:73], v250 offset:96
    ds_read_b64_tr_b16 v[74:75], v250 offset:16992
    ds_read_b64_tr_b16 v[76:77], v250 offset:33888
    ds_read_b64_tr_b16 v[78:79], v250 offset:50784
    ds_read_b64_tr_b16 v[80:81], v12 offset:128
    ds_read_b64_tr_b16 v[82:83], v12 offset:17024
    ds_read_b64_tr_b16 v[84:85], v12 offset:33920
    ds_read_b64_tr_b16 v[86:87], v12 offset:50816
    ds_read_b64_tr_b16 v[88:89], v250 offset:128
    ds_read_b64_tr_b16 v[90:91], v250 offset:17024
    ds_read_b64_tr_b16 v[92:93], v250 offset:33920
    ds_read_b64_tr_b16 v[94:95], v250 offset:50816
    ds_read_b64_tr_b16 v[96:97], v12 offset:160
    ds_read_b64_tr_b16 v[98:99], v12 offset:17056
    ds_read_b64_tr_b16 v[100:101], v12 offset:33952
    ds_read_b64_tr_b16 v[102:103], v12 offset:50848
    ds_read_b64_tr_b16 v[104:105], v250 offset:160
    ds_read_b64_tr_b16 v[106:107], v250 offset:17056
    ds_read_b64_tr_b16 v[108:109], v250 offset:33952
    ds_read_b64_tr_b16 v[110:111], v250 offset:50848
    ds_read_b64_tr_b16 v[112:113], v12 offset:192
    ds_read_b64_tr_b16 v[114:115], v12 offset:17088
    ds_read_b64_tr_b16 v[116:117], v12 offset:33984
    ds_read_b64_tr_b16 v[118:119], v12 offset:50880
    ds_read_b64_tr_b16 v[120:121], v250 offset:192
    ds_read_b64_tr_b16 v[122:123], v250 offset:17088
    ds_read_b64_tr_b16 v[124:125], v250 offset:33984
    ds_read_b64_tr_b16 v[126:127], v250 offset:50880
    ds_read_b64_tr_b16 v[128:129], v12 offset:224
    ds_read_b64_tr_b16 v[130:131], v12 offset:17120
    ds_read_b64_tr_b16 v[132:133], v12 offset:34016
    ds_read_b64_tr_b16 v[134:135], v12 offset:50912
    ds_read_b64_tr_b16 v[136:137], v250 offset:224
    ds_read_b64_tr_b16 v[138:139], v250 offset:17120
    ds_read_b64_tr_b16 v[140:141], v250 offset:34016
    ds_read_b64_tr_b16 v[142:143], v250 offset:50912
    s_setprio 2
L_fw_12:
    ds_read_b128 v[246:249], v2 offset:80
    ds_read_b128 v[176:179], v254 offset:6160
    ds_read_b128 v[180:183], v254 offset:7184
    ds_read_b128 v[184:187], v254 offset:8208
    ds_read_b128 v[188:191], v254 offset:9232
    ds_read_b128 v[196:199], v253 offset:2112
    s_waitcnt lgkmcnt(0)
    v_min3_u32 v246, v246, v247, v248
    v_min_u32 v246, v246, v249
    v_cmp_eq_u32 vcc, 0, v246
    s_cbranch_vccz L_fd_13
    s_sub_u32 s71, s71, 1
    s_cmp_gt_i32 s71, 0
    s_cbranch_scc1 L_fw_12
L_fd_13:
    s_cmp_lg_u32 s65, 0
    s_cbranch_scc1 L_nh_14
    v_mov_b32 v13, s70
    s_mov_b64 exec, 1
    buffer_store_dword v13, v2, s[28:31], s18 offen sc1
    s_mov_b64 exec, -1
L_nh_14:
    v_mfma_f32_16x16x32_bf16 v[144:147], v[16:19], v[176:179], 0
    v_max3_f32 v246, v196, v197, v198
    v_mfma_f32_16x16x32_bf16 v[144:147], v[20:23], v[180:183], v[144:147]
    v_max_f32 v246, v246, v199
    v_mfma_f32_16x16x32_bf16 v[144:147], v[24:27], v[184:187], v[144:147]
    v_mfma_f32_16x16x32_bf16 v[144:147], v[28:31], v[188:191], v[144:147]
    v_mfma_f32_16x16x32_bf16 v[148:151], v[32:35], v[176:179], 0
    v_mfma_f32_16x16x32_bf16 v[148:151], v[36:39], v[180:183], v[148:151]
    v_mfma_f32_16x16x32_bf16 v[148:151], v[40:43], v[184:187], v[148:151]
    v_mfma_f32_16x16x32_bf16 v[148:151], v[44:47], v[188:191], v[148:151]
    v_mfma_f32_16x16x32_bf16 v[152:155], v[48:51], v[176:179], 0
    v_mov_b32 v19, s70
    v_mov_b32 v23, s70
    v_mfma_f32_16x16x32_bf16 v[152:155], v[52:55], v[180:183], v[152:155]
    v_mov_b32 v27, s70
    v_mov_b32 v31, s70
    v_mfma_f32_16x16x32_bf16 v[152:155], v[56:59], v[184:187], v[152:155]
    v_mov_b32 v35, s70
    v_mov_b32 v39, s70
    v_mfma_f32_16x16x32_bf16 v[152:155], v[60:63], v[188:191], v[152:155]
    v_mov_b32 v37, v246
    v_cvt_pk_bf16_f32 v16, v144, v145
    v_cvt_pk_bf16_f32 v17, v146, v147
    v_mfma_f32_16x16x32_bf16 v[156:159], v[64:67], v[176:179], 0
    v_mfma_f32_16x16x32_bf16 v[156:159], v[68:71], v[180:183], v[156:159]
    v_mfma_f32_16x16x32_bf16 v[156:159], v[72:75], v[184:187], v[156:159]
    v_mfma_f32_16x16x32_bf16 v[156:159], v[76:79], v[188:191], v[156:159]
    v_cvt_pk_bf16_f32 v18, v148, v149
    buffer_store_dwordx4 v[16:19], v251, s[28:31], s13 offen offset:0 sc1
    v_cvt_pk_bf16_f32 v20, v150, v151
    v_mfma_f32_16x16x32_bf16 v[160:163], v[80:83], v[176:179], 0
    v_mfma_f32_16x16x32_bf16 v[160:163], v[84:87], v[180:183], v[160:163]
    v_mfma_f32_16x16x32_bf16 v[160:163], v[88:91], v[184:187], v[160:163]
    v_mfma_f32_16x16x32_bf16 v[160:163], v[92:95], v[188:191], v[160:163]
    v_cvt_pk_bf16_f32 v21, v152, v153
    v_cvt_pk_bf16_f32 v22, v154, v155
    buffer_store_dwordx4 v[20:23], v251, s[28:31], s13 offen offset:128 sc1
    v_mfma_f32_16x16x32_bf16 v[164:167], v[96:99], v[176:179], 0
    v_mfma_f32_16x16x32_bf16 v[164:167], v[100:103], v[180:183], v[164:167]
    v_mfma_f32_16x16x32_bf16 v[164:167], v[104:107], v[184:187], v[164:167]
    v_mfma_f32_16x16x32_bf16 v[164:167], v[108:111], v[188:191], v[164:167]
    v_mfma_f32_16x16x32_bf16 v[196:199], v[192:195], v[176:179], 0
    v_mfma_f32_16x16x32_bf16 v[196:199], v[192:195], v[180:183], v[196:199]
    v_mfma_f32_16x16x32_bf16 v[196:199], v[192:195], v[184:187], v[196:199]
    v_mfma_f32_16x16x32_bf16 v[196:199], v[192:195], v[188:191], v[196:199]
    v_cvt_pk_bf16_f32 v24, v156, v157
    v_cvt_pk_bf16_f32 v25, v158, v159
    v_mfma_f32_16x16x32_bf16 v[168:171], v[112:115], v[176:179], 0
    v_mfma_f32_16x16x32_bf16 v[168:171], v[116:119], v[180:183], v[168:171]
    v_mfma_f32_16x16x32_bf16 v[168:171], v[120:123], v[184:187], v[168:171]
    v_mfma_f32_16x16x32_bf16 v[168:171], v[124:127], v[188:191], v[168:171]
    v_cvt_pk_bf16_f32 v26, v160, v161
    buffer_store_dwordx4 v[24:27], v251, s[28:31], s13 offen offset:256 sc1
    v_cvt_pk_bf16_f32 v28, v162, v163
    v_mfma_f32_16x16x32_bf16 v[172:175], v[128:131], v[176:179], 0
    v_mfma_f32_16x16x32_bf16 v[172:175], v[132:135], v[180:183], v[172:175]
    v_mfma_f32_16x16x32_bf16 v[172:175], v[136:139], v[184:187], v[172:175]
    v_mfma_f32_16x16x32_bf16 v[172:175], v[140:143], v[188:191], v[172:175]
    v_cvt_pk_bf16_f32 v29, v164, v165
    v_cvt_pk_bf16_f32 v30, v166, v167
    buffer_store_dwordx4 v[28:31], v251, s[28:31], s13 offen offset:384 sc1
    v_cvt_pk_bf16_f32 v32, v168, v169
    v_cvt_pk_bf16_f32 v33, v170, v171
    s_nop 2
    v_cvt_pk_bf16_f32 v34, v172, v173
    buffer_store_dwordx4 v[32:35], v251, s[28:31], s13 offen offset:512 sc1
    v_cvt_pk_bf16_f32 v36, v174, v175
    v_mov_b32 v38, v196
    buffer_store_dwordx4 v[36:39], v251, s[28:31], s13 offen offset:640 sc1
    s_setprio 0
    s_cmp_eq_u32 s7, 0
    s_cbranch_scc1 L_fin
    s_waitcnt vmcnt(0)
    buffer_load_dwordx4 v[112:115], v10, s[28:31], s11 offen offset:0 sc1
    buffer_load_dwordx4 v[116:119], v10, s[28:31], s11 offen offset:1024 sc1
    buffer_load_dwordx4 v[44:47], v7, s[60:63], s9 offen offset:0 nt
    buffer_load_dword v60, v9, s[60:63], s9 offen offset:0 nt
    buffer_load_dwordx4 v[48:51], v7, s[60:63], s9 offen offset:1280 nt
    buffer_load_dword v61, v9, s[60:63], s9 offen offset:1280 nt
    buffer_load_dwordx4 v[52:55], v7, s[60:63], s9 offen offset:2560 nt
    buffer_load_dword v62, v9, s[60:63], s9 offen offset:2560 nt
    buffer_load_dwordx4 v[56:59], v7, s[60:63], s9 offen offset:3840 nt
    buffer_load_dword v63, v9, s[60:63], s9 offen offset:3840 nt
    v_mov_b32 v64, 0
    v_mov_b32 v65, 0
    v_mov_b32 v66, 0
    v_mov_b32 v67, 0
    v_mov_b32 v68, 0
    v_mov_b32 v69, 0
    v_mov_b32 v70, 0
    v_mov_b32 v71, 0
    s_waitcnt vmcnt(24)
    v_perm_b32 v72, v204, v200, s20
    v_perm_b32 v73, v204, v200, s21
    v_perm_b32 v74, v205, v201, s20
    v_perm_b32 v75, v205, v201, s21
    v_perm_b32 v76, v206, v202, s20
    v_perm_b32 v77, v206, v202, s21
    v_perm_b32 v78, v207, v203, s20
    v_perm_b32 v79, v207, v203, s21
    v_dot2c_f32_bf16 v64, v240, v72
    v_dot2c_f32_bf16 v65, v240, v73
    v_dot2c_f32_bf16 v66, v240, v74
    v_dot2c_f32_bf16 v67, v240, v75
    v_dot2c_f32_bf16 v68, v240, v76
    v_dot2c_f32_bf16 v69, v240, v77
    v_dot2c_f32_bf16 v70, v240, v78
    v_dot2c_f32_bf16 v71, v240, v79
    s_waitcnt vmcnt(22)
    v_perm_b32 v72, v212, v208, s20
    v_perm_b32 v73, v212, v208, s21
    v_perm_b32 v74, v213, v209, s20
    v_perm_b32 v75, v213, v209, s21
    v_perm_b32 v76, v214, v210, s20
    v_perm_b32 v77, v214, v210, s21
    v_perm_b32 v78, v215, v211, s20
    v_perm_b32 v79, v215, v211, s21
    v_dot2c_f32_bf16 v64, v241, v72
    v_dot2c_f32_bf16 v65, v241, v73
    v_dot2c_f32_bf16 v66, v241, v74
    v_dot2c_f32_bf16 v67, v241, v75
    v_dot2c_f32_bf16 v68, v241, v76
    v_dot2c_f32_bf16 v69, v241, v77
    v_dot2c_f32_bf16 v70, v241, v78
    v_dot2c_f32_bf16 v71, v241, v79
    s_waitcnt vmcnt(20)
    v_perm_b32 v72, v220, v216, s20
    v_perm_b32 v73, v220, v216, s21
    v_perm_b32 v74, v221, v217, s20
    v_perm_b32 v75, v221, v217, s21
    v_perm_b32 v76, v222, v218, s20
    v_perm_b32 v77, v222, v218, s21
    v_perm_b32 v78, v223, v219, s20
    v_perm_b32 v79, v223, v219, s21
    v_dot2c_f32_bf16 v64, v242, v72
    v_dot2c_f32_bf16 v65, v242, v73
    v_dot2c_f32_bf16 v66, v242, v74
    v_dot2c_f32_bf16 v67, v242, v75
    v_dot2c_f32_bf16 v68, v242, v76
    v_dot2c_f32_bf16 v69, v242, v77
    v_dot2c_f32_bf16 v70, v242, v78
    v_dot2c_f32_bf16 v71, v242, v79
    s_waitcnt vmcnt(18)
    v_perm_b32 v72, v228, v224, s20
    v_perm_b32 v73, v228, v224, s21
    v_perm_b32 v74, v229, v225, s20
    v_perm_b32 v75, v229, v225, s21
    v_perm_b32 v76, v230, v226, s20
    v_perm_b32 v77, v230, v226, s21
    v_perm_b32 v78, v231, v227, s20
    v_perm_b32 v79, v231, v227, s21
    v_dot2c_f32_bf16 v64, v243, v72
    v_dot2c_f32_bf16 v65, v243, v73
    v_dot2c_f32_bf16 v66, v243, v74
    v_dot2c_f32_bf16 v67, v243, v75
    v_dot2c_f32_bf16 v68, v243, v76
    v_dot2c_f32_bf16 v69, v243, v77
    v_dot2c_f32_bf16 v70, v243, v78
    v_dot2c_f32_bf16 v71, v243, v79
    s_waitcnt vmcnt(16)
    v_perm_b32 v72, v236, v232, s20
    v_perm_b32 v73, v236, v232, s21
    v_perm_b32 v74, v237, v233, s20
    v_perm_b32 v75, v237, v233, s21
    v_perm_b32 v76, v238, v234, s20
    v_perm_b32 v77, v238, v234, s21
    v_perm_b32 v78, v239, v235, s20
    v_perm_b32 v79, v239, v235, s21
    v_dot2c_f32_bf16 v64, v244, v72
    v_dot2c_f32_bf16 v65, v244, v73
    v_dot2c_f32_bf16 v66, v244, v74
    v_dot2c_f32_bf16 v67, v244, v75
    v_dot2c_f32_bf16 v68, v244, v76
    v_dot2c_f32_bf16 v69, v244, v77
    v_dot2c_f32_bf16 v70, v244, v78
    v_dot2c_f32_bf16 v71, v244, v79
    v_permlane32_swap_b32 v64, v68
    v_permlane32_swap_b32 v65, v69
    v_permlane32_swap_b32 v66, v70
    v_permlane32_swap_b32 v67, v71
    v_add_f32 v64, v64, v68
    v_add_f32 v65, v65, v69
    v_add_f32 v66, v66, v70
    v_add_f32 v67, v67, v71
    s_nop 0
    v_permlane16_swap_b32 v64, v66
    v_permlane16_swap_b32 v65, v67
    v_add_f32 v64, v64, v66
    v_add_f32 v65, v65, v67
    s_nop 0
    v_add_f32_dpp v64, v64, v64 row_ror:8 row_mask:0xf bank_mask:0xf
    v_add_f32_dpp v65, v65, v65 row_ror:8 row_mask:0xf bank_mask:0xf
    v_mov_b32 v66, 0
    v_mov_b32 v67, s70
    s_mov_b32 exec_lo, 0x00ff00ff
    s_mov_b32 exec_hi, 0x00ff00ff
    buffer_store_dwordx4 v[64:67], v252, s[28:31], s4 offen
    buffer_store_dwordx4 v[64:67], v252, s[28:31], s10 offen sc1
    s_mov_b64 exec, -1
    s_waitcnt vmcnt(2)
    v_perm_b32 v80, v48, v44, s20
    v_perm_b32 v81, v48, v44, s21
    v_perm_b32 v82, v49, v45, s20
    v_perm_b32 v83, v49, v45, s21
    v_perm_b32 v84, v50, v46, s20
    v_perm_b32 v85, v50, v46, s21
    v_perm_b32 v86, v51, v47, s20
    v_perm_b32 v87, v51, v47, s21
    v_perm_b32 v88, v61, v60, s20
    v_perm_b32 v89, v61, v60, s21
    v_perm_b32 v90, v56, v52, s20
    v_perm_b32 v91, v56, v52, s21
    v_perm_b32 v92, v57, v53, s20
    v_perm_b32 v93, v57, v53, s21
    v_perm_b32 v94, v58, v54, s20
    v_perm_b32 v95, v58, v54, s21
    v_perm_b32 v96, v59, v55, s20
    v_perm_b32 v97, v59, v55, s21
    v_perm_b32 v98, v63, v62, s20
    v_perm_b32 v99, v63, v62, s21
    v_mov_b32 v100, 0
    v_mov_b32 v101, 0
    v_mov_b32 v102, 0
    v_mov_b32 v103, 0
    v_mov_b32 v104, 0
    v_mov_b32 v105, 0
    v_mov_b32 v106, 0
    v_mov_b32 v107, 0
    v_mov_b32 v108, 0
    v_mov_b32 v109, 0
    v_mov_b32 v110, 0
    v_mov_b32 v111, 0
L_gr_15:
    buffer_load_dwordx4 v[112:115], v10, s[28:31], s11 offen offset:0 sc1
    buffer_load_dwordx4 v[116:119], v10, s[28:31], s11 offen offset:1024 sc1
    s_waitcnt vmcnt(0)
    v_cmpx_eq_u32 vcc, s70, v115
    v_cmpx_eq_u32 vcc, s70, v119
    s_nop 0
    s_cmp_eq_u64 exec, -1
    s_mov_b64 exec, -1
    s_cbranch_scc1 L_gd_16
    s_sleep 2
    s_add_u32 s12, s12, 1
    s_and_b32 s6, s12, 7
    s_cmp_eq_u32 s6, 7
    s_cselect_b32 s11, s5, s17
    s_sub_u32 s71, s71, 1
    s_cmp_gt_i32 s71, 0
    s_cbranch_scc1 L_gr_15
L_gd_16:
    v_add_f32_dpp v112, v112, v112 row_ror:8 row_mask:0xf bank_mask:0xf
    v_mov_b32 v72, v112
    s_nop 1
    v_permlane16_swap_b32 v72, v112
    v_add_f32 v112, v112, v72
    v_mov_b32 v72, v112
    s_nop 1
    v_permlane32_swap_b32 v72, v112
    v_add_f32 v112, v112, v72
    v_add_f32_dpp v113, v113, v113 row_ror:8 row_mask:0xf bank_mask:0xf
    v_mov_b32 v72, v113
    s_nop 1
    v_permlane16_swap_b32 v72, v113
    v_add_f32 v113, v113, v72
    v_mov_b32 v72, v113
    s_nop 1
    v_permlane32_swap_b32 v72, v113
    v_add_f32 v113, v113, v72
    v_add_f32_dpp v116, v116, v116 row_ror:8 row_mask:0xf bank_mask:0xf
    v_mov_b32 v72, v116
    s_nop 1
    v_permlane16_swap_b32 v72, v116
    v_add_f32 v116, v116, v72
    v_mov_b32 v72, v116
    s_nop 1
    v_permlane32_swap_b32 v72, v116
    v_add_f32 v116, v116, v72
    v_add_f32_dpp v117, v117, v117 row_ror:8 row_mask:0xf bank_mask:0xf
    v_mov_b32 v72, v117
    s_nop 1
    v_permlane16_swap_b32 v72, v117
    v_add_f32 v117, v117, v72
    v_mov_b32 v72, v117
    s_nop 1
    v_permlane32_swap_b32 v72, v117
    v_add_f32 v117, v117, v72
    v_cvt_pk_bf16_f32 v112, v112, v112
    v_and_b32 v112, 0xffff0000, v112
    v_cvt_pk_bf16_f32 v116, v116, v116
    v_and_b32 v116, 0xffff0000, v116
    v_mul_f32 v72, v112, v112
    v_mul_f32 v72, 0x3d372713, v72
    v_fma_f32 v72, v72, v112, v112
    v_mul_f32 v72, 0xc0135761, v72
    v_exp_f32 v72, v72
    s_nop 0
    v_add_f32 v72, 1.0, v72
    v_rcp_f32 v72, v72
    s_nop 0
    v_mul_f32 v112, v112, v72
    v_cvt_pk_bf16_f32 v112, v112, v112
    v_and_b32 v112, 0xffff0000, v112
    v_mul_f32 v112, v112, v116
    v_cvt_pk_bf16_f32 v113, v113, v113
    v_and_b32 v113, 0xffff0000, v113
    v_cvt_pk_bf16_f32 v117, v117, v117
    v_and_b32 v117, 0xffff0000, v117
    v_mul_f32 v72, v113, v113
    v_mul_f32 v72, 0x3d372713, v72
    v_fma_f32 v72, v72, v113, v113
    v_mul_f32 v72, 0xc0135761, v72
    v_exp_f32 v72, v72
    s_nop 0
    v_add_f32 v72, 1.0, v72
    v_rcp_f32 v72, v72
    s_nop 0
    v_mul_f32 v113, v113, v72
    v_cvt_pk_bf16_f32 v113, v113, v113
    v_and_b32 v113, 0xffff0000, v113
    v_mul_f32 v113, v113, v117
    v_cvt_pk_bf16_f32 v112, v112, v113
    s_lshl_b32 s14, s65, 5
    v_lshl_add_u32 v12, v11, 2, s14
    v_lshl_add_u32 v13, v14, 3, s14
    s_mov_b64 exec, 0xff
    ds_write_b32 v12, v112 offset:2944
    s_mov_b64 exec, -1
    ds_read_b64 v[114:115], v13 offset:2944
    s_waitcnt lgkmcnt(0)
    v_dot2c_f32_bf16 v100, v114, v80
    v_dot2c_f32_bf16 v101, v114, v81
    v_dot2c_f32_bf16 v102, v114, v82
    v_dot2c_f32_bf16 v103, v114, v83
    v_dot2c_f32_bf16 v104, v114, v84
    v_dot2c_f32_bf16 v105, v114, v85
    v_dot2c_f32_bf16 v106, v114, v86
    v_dot2c_f32_bf16 v107, v114, v87
    v_dot2c_f32_bf16 v108, v114, v88
    v_dot2c_f32_bf16 v109, v114, v89
    v_dot2c_f32_bf16 v100, v115, v90
    v_dot2c_f32_bf16 v101, v115, v91
    v_dot2c_f32_bf16 v102, v115, v92
    v_dot2c_f32_bf16 v103, v115, v93
    v_dot2c_f32_bf16 v104, v115, v94
    v_dot2c_f32_bf16 v105, v115, v95
    v_dot2c_f32_bf16 v106, v115, v96
    v_dot2c_f32_bf16 v107, v115, v97
    v_dot2c_f32_bf16 v108, v115, v98
    v_dot2c_f32_bf16 v109, v115, v99
    v_permlane32_swap_b32 v100, v106
    v_permlane32_swap_b32 v101, v107
    v_permlane32_swap_b32 v102, v108
    v_permlane32_swap_b32 v103, v109
    v_permlane32_swap_b32 v104, v110
    v_permlane32_swap_b32 v105, v111
    v_add_f32 v100, v100, v106
    v_add_f32 v101, v101, v107
    v_add_f32 v102, v102, v108
    v_add_f32 v103, v103, v109
    v_add_f32 v104, v104, v110
    v_add_f32 v105, v105, v111
    v_permlane16_swap_b32 v100, v103
    v_permlane16_swap_b32 v101, v104
    v_permlane16_swap_b32 v102, v105
    v_add_f32 v100, v100, v103
    v_add_f32 v101, v101, v104
    v_add_f32 v102, v102, v105
    v_mov_b32 v103, s70
    buffer_store_dwordx4 v[100:103], v5, s[28:31], s19 offen sc1
    s_branch L_fin
L_WX:
    s_lshl_b32 s10, s69, 2
    s_add_u32 s10, s10, s65
    s_lshl_b32 s10, s10, 11
    s_add_u32 s11, s10, 327680
    s_add_u32 s10, s10, 65536
    s_mov_b32 s12, 0
    s_mov_b32 s15, s10
    buffer_load_dwordx4 v[96:99], v11, s[28:31], s10 offen offset:0 sc1
    buffer_load_dwordx4 v[100:103], v11, s[28:31], s10 offen offset:1024 sc1
    s_load_dwordx2 s[24:25], s[0:1], 80
    s_mov_b32 s26, 1280
    s_mov_b32 s27, s3
    s_mov_b32 s71, 262144
    v_mov_b32 v3, 1
    s_lshl_b32 s6, s65, 2
    v_mov_b32 v4, s6
    s_mov_b32 s20, 0x05040100
    s_mov_b32 s21, 0x07060302
    s_lshl_b32 s18, s67, 3
    s_add_u32 s18, s18, s66
    s_lshl_b32 s18, s18, 7
    s_add_u32 s18, s18, 4096
    s_setprio 1
    v_lshrrev_b32 v12, 5, v1
    s_lshl_b32 s13, s65, 2
    v_add_u32 v12, s13, v12
    v_mul_u32_u24 v8, 288, v12
    v_and_b32 v12, 31, v1
    v_lshl_add_u32 v8, v12, 3, v8
    v_mul_u32_u24 v5, 288, v15
    v_lshl_add_u32 v5, v14, 4, v5
    v_xor_b32 v12, v14, v15
    v_lshlrev_b32 v12, 4, v12
    v_lshl_add_u32 v12, v15, 9, v12
    v_add_u32 v10, s9, v12
    s_lshr_b32 s13, s69, 4
    s_lshl_b32 s13, s13, 2
    s_add_u32 s13, s13, s7
    s_lshl_b32 s13, s13, 4
    s_and_b32 s14, s69, 15
    s_add_u32 s13, s13, s14
    s_lshl_b32 s13, s13, 2
    s_add_u32 s13, s13, s65
    s_lshl_b32 s13, s13, 7
    s_add_u32 s13, s13, 589824
    v_lshlrev_b32 v13, 3, v15
    v_mov_b32 v34, 0
    s_mov_b32 s14, 0x3e0293ee
    s_waitcnt lgkmcnt(0)
    s_mul_i32 s70, s70, 0x9E3779B1
    s_add_u32 s70, s70, 0x7F4A7C15
    v_mov_b32 v35, s70
L_fw_17:
    ds_read_b128 v[24:27], v2 offset:0
    s_waitcnt lgkmcnt(0)
    v_min_u32 v24, v24, v25
    v_cmp_eq_u32 vcc, 0, v24
    s_cbranch_vccz L_fd_18
    s_sub_u32 s71, s71, 1
    s_cmp_gt_i32 s71, 0
    s_cbranch_scc1 L_fw_17
L_fd_18:
    s_sleep 4
    buffer_load_dwordx4 v[96:99], v11, s[28:31], s10 offen offset:0 sc1
    buffer_load_dwordx4 v[100:103], v11, s[28:31], s10 offen offset:1024 sc1
    s_waitcnt vmcnt(2)
    v_xor_b32 v12, 0, v10
    ds_read_b128 v[64:67], v12 offset:0
    ds_read_b128 v[80:83], v12 offset:256
    v_xor_b32 v12, 64, v10
    ds_read_b128 v[68:71], v12 offset:0
    ds_read_b128 v[84:87], v12 offset:256
    v_xor_b32 v12, 128, v10
    ds_read_b128 v[72:75], v12 offset:0
    ds_read_b128 v[88:91], v12 offset:256
    v_xor_b32 v12, 192, v10
    ds_read_b128 v[76:79], v12 offset:0
    ds_read_b128 v[92:95], v12 offset:256
    s_waitcnt vmcnt(0)
    v_cmpx_eq_u32 vcc, s70, v99
    v_cmpx_eq_u32 vcc, s70, v103
    s_nop 0
    s_cmp_eq_u64 exec, -1
    s_mov_b64 exec, -1
    s_cbranch_scc1 L_gd_20
L_gr_19:
    buffer_load_dwordx4 v[96:99], v11, s[28:31], s10 offen offset:0 sc1
    buffer_load_dwordx4 v[100:103], v11, s[28:31], s10 offen offset:1024 sc1
    s_waitcnt vmcnt(0)
    v_cmpx_eq_u32 vcc, s70, v99
    v_cmpx_eq_u32 vcc, s70, v103
    s_nop 0
    s_cmp_eq_u64 exec, -1
    s_mov_b64 exec, -1
    s_cbranch_scc1 L_gd_20
    s_sleep 1
    s_add_u32 s12, s12, 1
    s_and_b32 s6, s12, 7
    s_cmp_eq_u32 s6, 7
    s_cselect_b32 s10, s11, s15
    s_sub_u32 s71, s71, 1
    s_cmp_gt_i32 s71, 0
    s_cbranch_scc1 L_gr_19
L_gd_20:
    ds_write_b64 v8, v[96:97] offset:11776
    ds_write_b64 v8, v[100:101] offset:12352
    s_mov_b64 exec, 1
    ds_write_b32 v4, v3 offset:16
    s_mov_b64 exec, -1
L_fw_21:
    ds_read_b128 v[24:27], v2 offset:16
    ds_read_b128 v[104:107], v5 offset:11776
    ds_read_b128 v[108:111], v5 offset:11840
    ds_read_b128 v[112:115], v5 offset:11904
    ds_read_b128 v[116:119], v5 offset:11968
    s_waitcnt lgkmcnt(0)
    v_min3_u32 v24, v24, v25, v26
    v_min_u32 v24, v24, v27
    v_cmp_eq_u32 vcc, 0, v24
    s_cbranch_vccz L_fd_22
    s_sub_u32 s71, s71, 1
    s_cmp_gt_i32 s71, 0
    s_cbranch_scc1 L_fw_21
L_fd_22:
    v_mfma_f32_16x16x32_bf16 v[120:123], v[104:107], v[64:67], 0
    v_mfma_f32_16x16x32_bf16 v[124:127], v[104:107], v[80:83], 0
    v_mfma_f32_16x16x32_bf16 v[120:123], v[108:111], v[68:71], v[120:123]
    v_mfma_f32_16x16x32_bf16 v[124:127], v[108:111], v[84:87], v[124:127]
    v_mfma_f32_16x16x32_bf16 v[120:123], v[112:115], v[72:75], v[120:123]
    v_mfma_f32_16x16x32_bf16 v[124:127], v[112:115], v[88:91], v[124:127]
    v_mfma_f32_16x16x32_bf16 v[120:123], v[116:119], v[76:79], v[120:123]
    v_mfma_f32_16x16x32_bf16 v[124:127], v[116:119], v[92:95], v[124:127]
    s_nop 6
    v_add_f32 v120, v120, v121
    v_add_f32 v122, v122, v123
    v_add_f32 v120, v120, v122
    v_add_f32 v124, v124, v125
    v_add_f32 v126, v126, v127
    v_add_f32 v124, v124, v126
    s_nop 1
    v_permlane32_swap_b32 v120, v124
    v_add_f32 v120, v120, v124
    v_mov_b32 v121, v120
    s_nop 1
    v_permlane16_swap_b32 v121, v120
    v_add_f32 v120, v120, v121
    v_mul_f32 v120, s14, v120
    v_mov_b32 v121, v120
    s_nop 1
    v_permlane32_swap_b32 v120, v121
    v_cvt_pk_bf16_f32 v32, v120, v121
    s_nop 1
    v_mov_b32_dpp v33, v32 quad_perm:[1,1,3,3] row_mask:0xf bank_mask:0xf
    s_mov_b64 exec, 0x5555
    buffer_store_dwordx4 v[32:35], v13, s[28:31], s13 offen sc1
    s_mov_b64 exec, 1
    ds_write_b32 v4, v3 offset:32
    s_mov_b64 exec, -1
    s_lshr_b32 s13, s69, 1
    s_lshl_b32 s13, s13, 2
    s_and_b32 s14, s67, 2
    s_add_u32 s13, s13, s14
    s_lshr_b32 s14, s65, 1
    s_add_u32 s13, s13, s14
    s_mul_i32 s13, s13, 49152
    s_and_b32 s14, s69, 1
    s_lshl_b32 s14, s14, 6
    s_add_u32 s13, s13, s14
    s_add_u32 s13, s13, 1048576
    s_and_b32 s15, s65, 1
    s_mul_i32 s14, s15, 384
    s_add_u32 s14, s14, s13
    v_lshrrev_b32 v12, 2, v1
    v_and_b32 v13, 3, v1
    v_mul_u32_u24 v7, 3072, v12
    v_lshl_add_u32 v7, v13, 4, v7
    v_mul_u32_u24 v8, 768, v1
    s_lshl_b32 s16, s65, 7
    v_lshl_add_u32 v9, v1, 1, s16
    v_lshl_add_u32 v10, v12, 3, s16
    v_mul_u32_u24 v11, 656, v12
    v_mul_u32_u24 v13, 80, v13
    s_lshr_b32 s16, s65, 1
    s_mul_i32 s16, s16, 320
    s_mul_i32 s15, s15, 36
    s_add_u32 s16, s16, s15
    s_add_u32 s16, s16, 16384
    v_add3_u32 v11, v11, v13, s16
    s_cmp_lg_u32 s65, 0
    s_cbranch_scc1 L_nohint
    s_mov_b64 exec, 1
L_hint_23:
    s_sleep 2
    buffer_load_dword v12, v2, s[28:31], s18 offen sc1
    s_waitcnt vmcnt(0)
    v_cmp_eq_u32 vcc, s70, v12
    s_cbranch_vccnz L_hintok
    s_sub_u32 s71, s71, 1
    s_cmp_gt_i32 s71, 0
    s_cbranch_scc1 L_hint_23
L_hintok:
    s_mov_b64 exec, 1
    ds_write_b32 v4, v3 offset:144
    s_mov_b64 exec, -1
L_nohint:
L_fw_24:
    ds_read_b128 v[24:27], v2 offset:144
    s_waitcnt lgkmcnt(0)
    v_cmp_eq_u32 vcc, 0, v24
    s_cbranch_vccz L_fd_25
    s_sleep 1
    s_sub_u32 s71, s71, 1
    s_cmp_gt_i32 s71, 0
    s_cbranch_scc1 L_fw_24
L_fd_25:
    s_sleep 8
L_g3again:
L_gr_26:
    buffer_load_dwordx4 v[112:115], v8, s[28:31], s13 offen offset:640 sc1
    s_waitcnt vmcnt(0)
    v_cmpx_eq_u32 vcc, s70, v115
    s_nop 0
    s_cmp_eq_u64 exec, -1
    s_mov_b64 exec, -1
    s_cbranch_scc1 L_gd_27
    s_sleep 2
    s_sub_u32 s71, s71, 1
    s_cmp_gt_i32 s71, 0
    s_cbranch_scc1 L_gr_26
L_gd_27:
    buffer_load_dwordx4 v[64:67], v7, s[28:31], s14 offen offset:0 sc1
    buffer_load_dwordx4 v[68:71], v7, s[28:31], s14 offen offset:768 sc1
    buffer_load_dwordx4 v[72:75], v7, s[28:31], s14 offen offset:1536 sc1
    buffer_load_dwordx4 v[76:79], v7, s[28:31], s14 offen offset:2304 sc1
    buffer_load_dwordx4 v[80:83], v7, s[28:31], s14 offen offset:128 sc1
    buffer_load_dwordx4 v[84:87], v7, s[28:31], s14 offen offset:896 sc1
    buffer_load_dwordx4 v[88:91], v7, s[28:31], s14 offen offset:1664 sc1
    buffer_load_dwordx4 v[92:95], v7, s[28:31], s14 offen offset:2432 sc1
    buffer_load_dwordx4 v[96:99], v7, s[28:31], s14 offen offset:256 sc1
    buffer_load_dwordx4 v[100:103], v7, s[28:31], s14 offen offset:1024 sc1
    buffer_load_dwordx4 v[104:107], v7, s[28:31], s14 offen offset:1792 sc1
    buffer_load_dwordx4 v[108:111], v7, s[28:31], s14 offen offset:2560 sc1
L_g3stat:
    v_mov_b32 v24, v113
    s_nop 1
    v_max_f32_dpp v24, v24, v24 row_ror:8 row_mask:0xf bank_mask:0xf
    s_nop 1
    v_max_f32_dpp v24, v24, v24 row_ror:4 row_mask:0xf bank_mask:0xf
    s_nop 1
    v_max_f32_dpp v24, v24, v24 row_ror:2 row_mask:0xf bank_mask:0xf
    s_nop 1
    v_max_f32_dpp v24, v24, v24 row_ror:1 row_mask:0xf bank_mask:0xf
    v_mov_b32 v26, v24
    s_nop 1
    v_permlane16_swap_b32 v26, v24
    v_max_f32 v24, v24, v26
    v_mov_b32 v26, v24
    s_nop 1
    v_permlane32_swap_b32 v26, v24
    v_max_f32 v24, v24, v26
    v_sub_f32 v25, v113, v24
    v_exp_f32 v25, v25
    s_nop 0
    ds_write_b16_d16_hi v9, v25 offset:3088
    ds_read_b64 v[28:29], v10 offset:3088
    v_mul_f32 v30, v25, v114
    s_nop 1
    v_add_f32_dpp v30, v30, v30 row_ror:8 row_mask:0xf bank_mask:0xf
    s_nop 1
    v_add_f32_dpp v30, v30, v30 row_ror:4 row_mask:0xf bank_mask:0xf
    s_nop 1
    v_add_f32_dpp v30, v30, v30 row_ror:2 row_mask:0xf bank_mask:0xf
    s_nop 1
    v_add_f32_dpp v30, v30, v30 row_ror:1 row_mask:0xf bank_mask:0xf
    v_mov_b32 v26, v30
    s_nop 1
    v_permlane16_swap_b32 v26, v30
    v_add_f32 v30, v30, v26
    v_mov_b32 v26, v30
    s_nop 1
    v_permlane32_swap_b32 v26, v30
    v_add_f32 v30, v30, v26
    v_rcp_f32 v30, v30
    s_waitcnt lgkmcnt(0)
    s_waitcnt vmcnt(10)
    v_perm_b32 v116, v68, v64, s20
    v_perm_b32 v117, v68, v64, s21
    v_perm_b32 v118, v69, v65, s20
    v_perm_b32 v119, v69, v65, s21
    v_perm_b32 v120, v70, v66, s20
    v_perm_b32 v121, v70, v66, s21
    v_dot2_f32_bf16 v152, v28, v116, 0
    v_dot2_f32_bf16 v153, v28, v117, 0
    v_dot2_f32_bf16 v154, v28, v118, 0
    v_dot2_f32_bf16 v155, v28, v119, 0
    v_dot2_f32_bf16 v156, v28, v120, 0
    v_dot2_f32_bf16 v157, v28, v121, 0
    s_waitcnt vmcnt(8)
    v_perm_b32 v116, v76, v72, s20
    v_perm_b32 v117, v76, v72, s21
    v_perm_b32 v118, v77, v73, s20
    v_perm_b32 v119, v77, v73, s21
    v_perm_b32 v120, v78, v74, s20
    v_perm_b32 v121, v78, v74, s21
    v_dot2_f32_bf16 v152, v29, v116, v152
    v_dot2_f32_bf16 v153, v29, v117, v153
    v_dot2_f32_bf16 v154, v29, v118, v154
    v_dot2_f32_bf16 v155, v29, v119, v155
    v_dot2_f32_bf16 v156, v29, v120, v156
    v_dot2_f32_bf16 v157, v29, v121, v157
    v_cmpx_eq_u32 vcc, s70, v67
    v_cmpx_eq_u32 vcc, s70, v71
    v_cmpx_eq_u32 vcc, s70, v75
    v_cmpx_eq_u32 vcc, s70, v79
    s_nop 0
    s_mov_b64 s[8:9], exec
    s_mov_b64 exec, -1
    s_waitcnt vmcnt(6)
    v_perm_b32 v116, v84, v80, s20
    v_perm_b32 v117, v84, v80, s21
    v_perm_b32 v118, v85, v81, s20
    v_perm_b32 v119, v85, v81, s21
    v_perm_b32 v120, v86, v82, s20
    v_perm_b32 v121, v86, v82, s21
    v_dot2_f32_bf16 v158, v28, v116, 0
    v_dot2_f32_bf16 v159, v28, v117, 0
    v_dot2_f32_bf16 v160, v28, v118, 0
    v_dot2_f32_bf16 v161, v28, v119, 0
    v_dot2_f32_bf16 v162, v28, v120, 0
    v_dot2_f32_bf16 v163, v28, v121, 0
    s_waitcnt vmcnt(4)
    v_perm_b32 v116, v92, v88, s20
    v_perm_b32 v117, v92, v88, s21
    v_perm_b32 v118, v93, v89, s20
    v_perm_b32 v119, v93, v89, s21
    v_perm_b32 v120, v94, v90, s20
    v_perm_b32 v121, v94, v90, s21
    v_dot2_f32_bf16 v158, v29, v116, v158
    v_dot2_f32_bf16 v159, v29, v117, v159
    v_dot2_f32_bf16 v160, v29, v118, v160
    v_dot2_f32_bf16 v161, v29, v119, v161
    v_dot2_f32_bf16 v162, v29, v120, v162
    v_dot2_f32_bf16 v163, v29, v121, v163
    v_cmpx_eq_u32 vcc, s70, v83
    v_cmpx_eq_u32 vcc, s70, v87
    v_cmpx_eq_u32 vcc, s70, v91
    v_cmpx_eq_u32 vcc, s70, v95
    s_nop 0
    s_mov_b64 s[10:11], exec
    s_mov_b64 exec, -1
    s_waitcnt vmcnt(2)
    v_perm_b32 v116, v100, v96, s20
    v_perm_b32 v117, v100, v96, s21
    v_perm_b32 v118, v101, v97, s20
    v_perm_b32 v119, v101, v97, s21
    v_perm_b32 v120, v102, v98, s20
    v_perm_b32 v121, v102, v98, s21
    v_dot2_f32_bf16 v164, v28, v116, 0
    v_dot2_f32_bf16 v165, v28, v117, 0
    v_dot2_f32_bf16 v166, v28, v118, 0
    v_dot2_f32_bf16 v167, v28, v119, 0
    v_dot2_f32_bf16 v168, v28, v120, 0
    v_dot2_f32_bf16 v169, v28, v121, 0
    s_waitcnt vmcnt(0)
    v_perm_b32 v116, v108, v104, s20
    v_perm_b32 v117, v108, v104, s21
    v_perm_b32 v118, v109, v105, s20
    v_perm_b32 v119, v109, v105, s21
    v_perm_b32 v120, v110, v106, s20
    v_perm_b32 v121, v110, v106, s21
    v_dot2_f32_bf16 v164, v29, v116, v164
    v_dot2_f32_bf16 v165, v29, v117, v165
    v_dot2_f32_bf16 v166, v29, v118, v166
    v_dot2_f32_bf16 v167, v29, v119, v167
    v_dot2_f32_bf16 v168, v29, v120, v168
    v_dot2_f32_bf16 v169, v29, v121, v169
    v_cmpx_eq_u32 vcc, s70, v99
    v_cmpx_eq_u32 vcc, s70, v103
    v_cmpx_eq_u32 vcc, s70, v107
    v_cmpx_eq_u32 vcc, s70, v111
    s_and_b64 s[8:9], s[8:9], s[10:11]
    s_and_b64 s[8:9], s[8:9], exec
    s_mov_b64 exec, -1
    s_cmp_eq_u64 s[8:9], -1
    s_cbranch_scc1 L_g3ok
    s_sub_u32 s71, s71, 1
    s_cmp_gt_i32 s71, 0
    s_cbranch_scc1 L_g3again
L_g3ok:
    v_cvt_pk_bf16_f32 v152, v152, v153
    v_cvt_pk_bf16_f32 v153, v154, v155
    v_cvt_pk_bf16_f32 v154, v156, v157
    v_cvt_pk_bf16_f32 v155, v158, v159
    v_cvt_pk_bf16_f32 v156, v160, v161
    v_cvt_pk_bf16_f32 v157, v162, v163
    v_cvt_pk_bf16_f32 v158, v164, v165
    v_cvt_pk_bf16_f32 v159, v166, v167
    v_cvt_pk_bf16_f32 v160, v168, v169
    ds_write2_b32 v11, v152, v153 offset0:0 offset1:1
    ds_write2_b32 v11, v154, v155 offset0:2 offset1:3
    ds_write2_b32 v11, v156, v157 offset0:4 offset1:5
    ds_write2_b32 v11, v158, v159 offset0:6 offset1:7
    ds_write_b32 v11, v160 offset:32
    s_mov_b64 exec, 1
    ds_write_b32 v2, v30 offset:3072
    s_mov_b64 exec, 1
    ds_write_b32 v4, v3 offset:96
    s_mov_b64 exec, -1
    s_cmp_lg_u32 s65, 3
    s_cbranch_scc1 L_fin
    s_lshr_b32 s12, s67, 2
    s_lshl_b32 s14, s12, 3
    s_add_u32 s14, s14, s66
    s_lshl_b32 s14, s14, 2
    s_and_b32 s13, s67, 3
    s_add_u32 s14, s14, s13
    s_lshl_b32 s14, s14, 5
    s_lshr_b32 s16, s13, 1
    s_lshl_b32 s17, s66, 1
    s_add_u32 s16, s16, s17
    s_and_b32 s17, s67, 1
    s_mul_i32 s17, s17, 6
    v_lshlrev_b32 v12, 1, v14
    v_mov_b32 v13, 0x98
    v_bfe_u32 v12, v13, v12, 2
    v_and_b32 v13, 1, v1
    v_mul_u32_u24 v9, 3, v13
    v_add3_u32 v12, v12, v9, s17
    s_lshl_b32 s18, s12, 7
    s_lshl_b32 s19, s16, 3
    s_add_u32 s18, s18, s19
    s_lshl_b32 s19, s12, 5
    s_lshl_b32 s16, s16, 1
    s_add_u32 s19, s19, s16
    s_add_u32 s19, s19, 504
    v_add_u32 v10, s18, v12
    v_add_u32 v7, s19, v12
    v_cmp_gt_u32 vcc, 8, v12
    s_nop 1
    v_cndmask_b32 v7, v7, v10, vcc
    v_lshlrev_b32 v7, 1, v7
    v_cmp_gt_u32 vcc, 10, v12
    s_mov_b32 s16, 0x00030003
    s_mov_b32 s17, 0x00000003
    s_and_b64 s[16:17], s[16:17], vcc
    v_mov_b32 v10, 0x10000
    v_cndmask_b32 v7, v10, v7, s[16:17]
    buffer_load_ushort v8, v7, s[32:35], 0 offen
    v_lshrrev_b32 v9, 1, v1
    v_lshlrev_b32 v9, 12, v9
    v_lshl_add_u32 v9, v13, 4, v9
    s_add_u32 s4, s14, 6291456
    s_add_u32 s8, s14, 5242880
    s_add_u32 s5, s4, 131072
    s_add_u32 s9, s8, 131072
    s_add_u32 s6, s4, 262144
    s_add_u32 s10, s8, 262144
    s_add_u32 s7, s4, 393216
    s_add_u32 s11, s8, 393216
    s_mov_b32 s18, 0x003f003f
    s_mov_b32 s19, 0x003f003f
    v_mov_b32 v76, 0
    v_mov_b32 v77, 0
    v_mov_b32 v78, 0
    v_mov_b32 v79, s70
L_fw_28:
    ds_read_b128 v[28:31], v2 offset:160
    s_waitcnt lgkmcnt(0)
    v_min3_u32 v28, v28, v29, v30
    v_min_u32 v28, v28, v31
    v_cmp_eq_u32 vcc, 0, v28
    s_cbranch_vccz L_fd_29
    s_sub_u32 s71, s71, 1
    s_cmp_gt_i32 s71, 0
    s_cbranch_scc1 L_fw_28
L_fd_29:
    s_sleep 10
    buffer_load_dwordx4 v[64:67], v9, s[28:31], s4 offen sc1
    buffer_load_dwordx4 v[68:71], v9, s[28:31], s5 offen sc1
    buffer_load_dwordx4 v[72:75], v9, s[28:31], s6 offen sc1
    s_mov_b64 exec, s[18:19]
    buffer_load_dwordx4 v[76:79], v9, s[28:31], s7 offen sc1
    s_mov_b64 exec, -1
    buffer_load_dwordx4 v[80:83], v9, s[28:31], s8 offen sc1
    buffer_load_dwordx4 v[84:87], v9, s[28:31], s9 offen sc1
    buffer_load_dwordx4 v[88:91], v9, s[28:31], s10 offen sc1
    buffer_load_dwordx4 v[92:95], v9, s[28:31], s11 offen sc1
    s_waitcnt vmcnt(4)
    v_cmpx_eq_u32 vcc, s70, v67
    v_cmpx_eq_u32 vcc, s70, v71
    v_cmpx_eq_u32 vcc, s70, v75
    v_cmpx_eq_u32 vcc, s70, v79
    s_nop 0
    s_cmp_eq_u64 exec, -1
    s_mov_b64 exec, -1
    s_cbranch_scc1 L_gd_31
L_gr_30:
    buffer_load_dwordx4 v[64:67], v9, s[28:31], s4 offen sc1
    buffer_load_dwordx4 v[68:71], v9, s[28:31], s5 offen sc1
    buffer_load_dwordx4 v[72:75], v9, s[28:31], s6 offen sc1
    s_mov_b64 exec, s[18:19]
    buffer_load_dwordx4 v[76:79], v9, s[28:31], s7 offen sc1
    s_mov_b64 exec, -1
    s_waitcnt vmcnt(0)
    v_cmpx_eq_u32 vcc, s70, v67
    v_cmpx_eq_u32 vcc, s70, v71
    v_cmpx_eq_u32 vcc, s70, v75
    v_cmpx_eq_u32 vcc, s70, v79
    s_nop 0
    s_cmp_eq_u64 exec, -1
    s_mov_b64 exec, -1
    s_cbranch_scc1 L_gd_31
    s_sleep 1
    s_sub_u32 s71, s71, 1
    s_cmp_gt_i32 s71, 0
    s_cbranch_scc1 L_gr_30
L_gd_31:
    v_add_f32 v64, v64, v68
    v_add_f32 v72, v72, v76
    v_add_f32 v65, v65, v69
    v_add_f32 v73, v73, v77
    v_add_f32 v66, v66, v70
    v_add_f32 v74, v74, v78
    v_add_f32 v64, v64, v72
    v_add_f32 v65, v65, v73
    v_add_f32 v66, v66, v74
    v_mov_b32 v25, v66
    v_permlane32_swap_b32 v64, v65
    s_nop 0
    v_permlane32_swap_b32 v25, v66
    v_add_f32 v64, v64, v65
    v_add_f32 v25, v25, v66
    s_nop 1
    v_permlane16_swap_b32 v64, v25
    v_add_f32 v24, v64, v25
    s_nop 1
    v_add_f32_dpp v24, v24, v24 row_ror:8 row_mask:0xf bank_mask:0xf
    s_nop 1
    v_add_f32_dpp v24, v24, v24 row_ror:4 row_mask:0xf bank_mask:0xf
    s_nop 1
    v_add_f32_dpp v24, v24, v24 row_ror:2 row_mask:0xf bank_mask:0xf
    v_cvt_pk_bf16_f32 v24, v24, v24
    v_and_b32 v24, 0xffff0000, v24
    v_mul_f32 v25, 0xbfb8aa3b, v24
    v_exp_f32 v25, v25
    s_nop 0
    v_add_f32 v25, 1.0, v25
    v_rcp_f32 v25, v25
    s_nop 0
    v_mul_f32 v24, v24, v25
    v_cvt_pk_bf16_f32 v24, v24, v24
    v_and_b32 v24, 0xffff0000, v24
    v_lshlrev_b32 v8, 16, v8
    s_waitcnt vmcnt(0)
    v_cmpx_eq_u32 vcc, s70, v83
    v_cmpx_eq_u32 vcc, s70, v87
    v_cmpx_eq_u32 vcc, s70, v91
    v_cmpx_eq_u32 vcc, s70, v95
    s_nop 0
    s_cmp_eq_u64 exec, -1
    s_mov_b64 exec, -1
    s_cbranch_scc1 L_gd_33
L_gr_32:
    buffer_load_dwordx4 v[80:83], v9, s[28:31], s8 offen sc1
    buffer_load_dwordx4 v[84:87], v9, s[28:31], s9 offen sc1
    buffer_load_dwordx4 v[88:91], v9, s[28:31], s10 offen sc1
    buffer_load_dwordx4 v[92:95], v9, s[28:31], s11 offen sc1
    s_waitcnt vmcnt(0)
    v_cmpx_eq_u32 vcc, s70, v83
    v_cmpx_eq_u32 vcc, s70, v87
    v_cmpx_eq_u32 vcc, s70, v91
    v_cmpx_eq_u32 vcc, s70, v95
    s_nop 0
    s_cmp_eq_u64 exec, -1
    s_mov_b64 exec, -1
    s_cbranch_scc1 L_gd_33
    s_sleep 1
    s_sub_u32 s71, s71, 1
    s_cmp_gt_i32 s71, 0
    s_cbranch_scc1 L_gr_32
L_gd_33:
    v_add_f32 v80, v80, v84
    v_add_f32 v88, v88, v92
    v_add_f32 v81, v81, v85
    v_add_f32 v89, v89, v93
    v_add_f32 v82, v82, v86
    v_add_f32 v90, v90, v94
    v_add_f32 v80, v80, v88
    v_add_f32 v81, v81, v89
    v_add_f32 v82, v82, v90
    v_mov_b32 v25, v82
    v_permlane32_swap_b32 v80, v81
    s_nop 0
    v_permlane32_swap_b32 v25, v82
    v_add_f32 v80, v80, v81
    v_add_f32 v25, v25, v82
    s_nop 1
    v_permlane16_swap_b32 v80, v25
    v_add_f32 v26, v80, v25
    s_nop 1
    v_add_f32_dpp v26, v26, v26 row_ror:8 row_mask:0xf bank_mask:0xf
    s_nop 1
    v_add_f32_dpp v26, v26, v26 row_ror:4 row_mask:0xf bank_mask:0xf
    s_nop 1
    v_add_f32_dpp v26, v26, v26 row_ror:2 row_mask:0xf bank_mask:0xf
    v_cvt_pk_bf16_f32 v26, v26, v26
    v_and_b32 v26, 0xffff0000, v26
    v_mul_f32 v26, v26, v24
    v_cvt_pk_bf16_f32 v26, v26, v26
    v_and_b32 v26, 0xffff0000, v26
    v_add_f32 v26, v26, v8
    v_cvt_pk_bf16_f32 v26, v26, v26
    buffer_store_short v26, v7, s[24:27], 0 offen
    s_cmp_lg_u32 s2, 0
    s_cbranch_scc1 L_fin
    v_mov_b32 v12, s70
    s_mov_b64 exec, 1
    buffer_store_dword v12, v2, s[28:31], 0 offen offset:0 sc1
    s_branch L_fin
L_CX:
    s_and_b32 s7, s67, 1
    s_lshl_b32 s10, s7, 2
    s_add_u32 s10, s10, s65
    s_lshl_b32 s10, s10, 13
    s_add_u32 s10, s10, 589824
    s_add_u32 s11, s10, 4096
    s_mov_b32 s71, 262144
    v_mov_b32 v3, 1
    s_lshl_b32 s6, s65, 2
    v_mov_b32 v4, s6
    s_mov_b32 s20, 0x05040100
    s_mov_b32 s21, 0x07060302
    s_lshl_b32 s18, s67, 3
    s_add_u32 s18, s18, s66
    s_lshl_b32 s18, s18, 7
    s_add_u32 s18, s18, 4096
    s_setprio 1
    v_lshrrev_b32 v12, 5, v1
    v_mul_u32_u24 v7, 1056, v12
    v_and_b32 v12, 31, v1
    v_lshl_add_u32 v7, v12, 3, v7
    s_lshl_b32 s12, s65, 8
    v_add_u32 v7, s12, v7
    v_mul_u32_u24 v5, 1056, v15
    v_lshl_add_u32 v5, v14, 4, v5
    v_add_u32 v8, s9, v5
    s_lshl_b32 s12, s65, 2
    v_lshl_add_u32 v10, v15, 4, s12
    v_lshlrev_b32 v13, 4, v15
    s_lshl_b32 s12, s65, 10
    v_add_u32 v6, s12, v11
    s_waitcnt lgkmcnt(0)
    s_mul_i32 s70, s70, 0x9E3779B1
    s_add_u32 s70, s70, 0x7F4A7C15
    s_waitcnt vmcnt(16)
    ds_read_b128 v[64:67], v8 offset:0
    ds_read_b128 v[68:71], v8 offset:64
    ds_read_b128 v[72:75], v8 offset:128
    ds_read_b128 v[76:79], v8 offset:192
    ds_read_b128 v[80:83], v8 offset:256
    ds_read_b128 v[84:87], v8 offset:320
    ds_read_b128 v[88:91], v8 offset:384
    ds_read_b128 v[92:95], v8 offset:448
    ds_read_b128 v[96:99], v8 offset:512
    ds_read_b128 v[100:103], v8 offset:576
    ds_read_b128 v[104:107], v8 offset:640
    ds_read_b128 v[108:111], v8 offset:704
    ds_read_b128 v[112:115], v8 offset:768
    ds_read_b128 v[116:119], v8 offset:832
    ds_read_b128 v[120:123], v8 offset:896
    ds_read_b128 v[124:127], v8 offset:960
    s_waitcnt vmcnt(0)
    buffer_load_dwordx4 v[192:195], v11, s[28:31], s10 offen offset:0 sc1
    buffer_load_dwordx4 v[196:199], v11, s[28:31], s10 offen offset:1024 sc1
    buffer_load_dwordx4 v[200:203], v11, s[28:31], s10 offen offset:2048 sc1
    buffer_load_dwordx4 v[204:207], v11, s[28:31], s10 offen offset:3072 sc1
    buffer_load_dwordx4 v[208:211], v11, s[28:31], s11 offen offset:0 sc1
    buffer_load_dwordx4 v[212:215], v11, s[28:31], s11 offen offset:1024 sc1
    buffer_load_dwordx4 v[216:219], v11, s[28:31], s11 offen offset:2048 sc1
    buffer_load_dwordx4 v[220:223], v11, s[28:31], s11 offen offset:3072 sc1
    s_waitcnt vmcnt(8)
    s_mov_b64 exec, 1
    ds_write_b32 v4, v3 offset:128
    s_mov_b64 exec, -1
    ds_read_b128 v[128:131], v8 offset:16896
    ds_read_b128 v[132:135], v8 offset:16960
    ds_read_b128 v[136:139], v8 offset:17024
    ds_read_b128 v[140:143], v8 offset:17088
    ds_read_b128 v[144:147], v8 offset:17152
    ds_read_b128 v[148:151], v8 offset:17216
    ds_read_b128 v[152:155], v8 offset:17280
    ds_read_b128 v[156:159], v8 offset:17344
    ds_read_b128 v[160:163], v8 offset:17408
    ds_read_b128 v[164:167], v8 offset:17472
    ds_read_b128 v[168:171], v8 offset:17536
    ds_read_b128 v[172:175], v8 offset:17600
    ds_read_b128 v[176:179], v8 offset:17664
    ds_read_b128 v[180:183], v8 offset:17728
    ds_read_b128 v[184:187], v8 offset:17792
    ds_read_b128 v[188:191], v8 offset:17856
    s_waitcnt vmcnt(0)
    v_cmpx_eq_u32 vcc, s70, v195
    v_cmpx_eq_u32 vcc, s70, v199
    v_cmpx_eq_u32 vcc, s70, v203
    v_cmpx_eq_u32 vcc, s70, v207
    v_cmpx_eq_u32 vcc, s70, v211
    v_cmpx_eq_u32 vcc, s70, v215
    v_cmpx_eq_u32 vcc, s70, v219
    v_cmpx_eq_u32 vcc, s70, v223
    s_nop 0
    s_cmp_eq_u64 exec, -1
    s_mov_b64 exec, -1
    s_cbranch_scc1 L_gd_35
L_gr_34:
    buffer_load_dwordx4 v[192:195], v11, s[28:31], s10 offen offset:0 sc1
    buffer_load_dwordx4 v[196:199], v11, s[28:31], s10 offen offset:1024 sc1
    buffer_load_dwordx4 v[200:203], v11, s[28:31], s10 offen offset:2048 sc1
    buffer_load_dwordx4 v[204:207], v11, s[28:31], s10 offen offset:3072 sc1
    buffer_load_dwordx4 v[208:211], v11, s[28:31], s11 offen offset:0 sc1
    buffer_load_dwordx4 v[212:215], v11, s[28:31], s11 offen offset:1024 sc1
    buffer_load_dwordx4 v[216:219], v11, s[28:31], s11 offen offset:2048 sc1
    buffer_load_dwordx4 v[220:223], v11, s[28:31], s11 offen offset:3072 sc1
    s_waitcnt vmcnt(0)
    v_cmpx_eq_u32 vcc, s70, v195
    v_cmpx_eq_u32 vcc, s70, v199
    v_cmpx_eq_u32 vcc, s70, v203
    v_cmpx_eq_u32 vcc, s70, v207
    v_cmpx_eq_u32 vcc, s70, v211
    v_cmpx_eq_u32 vcc, s70, v215
    v_cmpx_eq_u32 vcc, s70, v219
    v_cmpx_eq_u32 vcc, s70, v223
    s_nop 0
    s_cmp_eq_u64 exec, -1
    s_mov_b64 exec, -1
    s_cbranch_scc1 L_gd_35
    s_sleep 2
    s_sub_u32 s71, s71, 1
    s_cmp_gt_i32 s71, 0
    s_cbranch_scc1 L_gr_34
L_gd_35:
    ds_write_b64 v7, v[192:193] offset:11776
    ds_write_b64 v7, v[196:197] offset:13888
    ds_write_b64 v7, v[200:201] offset:16000
    ds_write_b64 v7, v[204:205] offset:18112
    ds_write_b64 v7, v[208:209] offset:20224
    ds_write_b64 v7, v[212:213] offset:22336
    ds_write_b64 v7, v[216:217] offset:24448
    ds_write_b64 v7, v[220:221] offset:26560
    s_mov_b64 exec, 1
    ds_write_b32 v4, v3 offset:48
    s_mov_b64 exec, -1
L_fw_36:
    ds_read_b128 v[24:27], v2 offset:48
    s_waitcnt lgkmcnt(0)
    v_min3_u32 v24, v24, v25, v26
    v_min_u32 v24, v24, v27
    v_cmp_eq_u32 vcc, 0, v24
    s_cbranch_vccz L_fd_37
    s_sub_u32 s71, s71, 1
    s_cmp_gt_i32 s71, 0
    s_cbranch_scc1 L_fw_36
L_fd_37:
    ds_read_b128 v[192:195], v5 offset:11776
    ds_read_b128 v[196:199], v5 offset:11840
    ds_read_b128 v[200:203], v5 offset:11904
    ds_read_b128 v[204:207], v5 offset:11968
    ds_read_b128 v[208:211], v5 offset:12032
    ds_read_b128 v[212:215], v5 offset:12096
    ds_read_b128 v[216:219], v5 offset:12160
    s_waitcnt lgkmcnt(6)
    v_mfma_f32_16x16x32_bf16 v[16:19], v[64:67], v[192:195], 0
    v_mfma_f32_16x16x32_bf16 v[20:23], v[128:131], v[192:195], 0
    ds_read_b128 v[220:223], v5 offset:12224
    s_waitcnt lgkmcnt(6)
    v_mfma_f32_16x16x32_bf16 v[16:19], v[68:71], v[196:199], v[16:19]
    v_mfma_f32_16x16x32_bf16 v[20:23], v[132:135], v[196:199], v[20:23]
    ds_read_b128 v[224:227], v5 offset:12288
    s_waitcnt lgkmcnt(6)
    v_mfma_f32_16x16x32_bf16 v[16:19], v[72:75], v[200:203], v[16:19]
    v_mfma_f32_16x16x32_bf16 v[20:23], v[136:139], v[200:203], v[20:23]
    ds_read_b128 v[228:231], v5 offset:12352
    s_waitcnt lgkmcnt(6)
    v_mfma_f32_16x16x32_bf16 v[16:19], v[76:79], v[204:207], v[16:19]
    v_mfma_f32_16x16x32_bf16 v[20:23], v[140:143], v[204:207], v[20:23]
    ds_read_b128 v[232:235], v5 offset:12416
    s_waitcnt lgkmcnt(6)
    v_mfma_f32_16x16x32_bf16 v[16:19], v[80:83], v[208:211], v[16:19]
    v_mfma_f32_16x16x32_bf16 v[20:23], v[144:147], v[208:211], v[20:23]
    ds_read_b128 v[236:239], v5 offset:12480
    s_waitcnt lgkmcnt(6)
    v_mfma_f32_16x16x32_bf16 v[16:19], v[84:87], v[212:215], v[16:19]
    v_mfma_f32_16x16x32_bf16 v[20:23], v[148:151], v[212:215], v[20:23]
    ds_read_b128 v[240:243], v5 offset:12544
    s_waitcnt lgkmcnt(6)
    v_mfma_f32_16x16x32_bf16 v[16:19], v[88:91], v[216:219], v[16:19]
    v_mfma_f32_16x16x32_bf16 v[20:23], v[152:155], v[216:219], v[20:23]
    ds_read_b128 v[244:247], v5 offset:12608
    s_waitcnt lgkmcnt(6)
    v_mfma_f32_16x16x32_bf16 v[16:19], v[92:95], v[220:223], v[16:19]
    v_mfma_f32_16x16x32_bf16 v[20:23], v[156:159], v[220:223], v[20:23]
    ds_read_b128 v[248:251], v5 offset:12672
    s_waitcnt lgkmcnt(6)
    v_mfma_f32_16x16x32_bf16 v[16:19], v[96:99], v[224:227], v[16:19]
    v_mfma_f32_16x16x32_bf16 v[20:23], v[160:163], v[224:227], v[20:23]
    ds_read_b128 v[252:255], v5 offset:12736
    s_waitcnt lgkmcnt(6)
    v_mfma_f32_16x16x32_bf16 v[16:19], v[100:103], v[228:231], v[16:19]
    v_mfma_f32_16x16x32_bf16 v[20:23], v[164:167], v[228:231], v[20:23]
    s_waitcnt lgkmcnt(5)
    v_mfma_f32_16x16x32_bf16 v[16:19], v[104:107], v[232:235], v[16:19]
    v_mfma_f32_16x16x32_bf16 v[20:23], v[168:171], v[232:235], v[20:23]
    s_waitcnt lgkmcnt(4)
    v_mfma_f32_16x16x32_bf16 v[16:19], v[108:111], v[236:239], v[16:19]
    v_mfma_f32_16x16x32_bf16 v[20:23], v[172:175], v[236:239], v[20:23]
    s_waitcnt lgkmcnt(3)
    v_mfma_f32_16x16x32_bf16 v[16:19], v[112:115], v[240:243], v[16:19]
    v_mfma_f32_16x16x32_bf16 v[20:23], v[176:179], v[240:243], v[20:23]
    s_waitcnt lgkmcnt(2)
    v_mfma_f32_16x16x32_bf16 v[16:19], v[116:119], v[244:247], v[16:19]
    v_mfma_f32_16x16x32_bf16 v[20:23], v[180:183], v[244:247], v[20:23]
    s_waitcnt lgkmcnt(1)
    v_mfma_f32_16x16x32_bf16 v[16:19], v[120:123], v[248:251], v[16:19]
    v_mfma_f32_16x16x32_bf16 v[20:23], v[184:187], v[248:251], v[20:23]
    s_waitcnt lgkmcnt(0)
    v_mfma_f32_16x16x32_bf16 v[16:19], v[124:127], v[252:255], v[16:19]
    v_mfma_f32_16x16x32_bf16 v[20:23], v[188:191], v[252:255], v[20:23]
    s_nop 6
    v_max3_f32 v28, v16, v17, v18
    v_max3_f32 v28, v28, v19, v20
    v_max3_f32 v28, v28, v21, v22
    v_max_f32 v28, v28, v23
    v_mov_b32 v29, v28
    s_nop 1
    v_permlane16_swap_b32 v29, v28
    v_max_f32 v28, v28, v29
    v_mov_b32 v29, v28
    s_nop 1
    v_permlane32_swap_b32 v29, v28
    v_max_f32 v28, v28, v29
    v_ceil_f32 v28, v28
    s_mov_b64 exec, 0xffff
    ds_write_b32 v10, v28 offset:2112
    s_mov_b64 exec, 1
    ds_write_b32 v4, v3 offset:64
    s_mov_b64 exec, -1
L_fw_38:
    ds_read_b128 v[24:27], v2 offset:64
    ds_read_b128 v[32:35], v13 offset:2112
    s_waitcnt lgkmcnt(0)
    v_min3_u32 v24, v24, v25, v26
    v_min_u32 v24, v24, v27
    v_cmp_eq_u32 vcc, 0, v24
    s_cbranch_vccz L_fd_39
    s_sub_u32 s71, s71, 1
    s_cmp_gt_i32 s71, 0
    s_cbranch_scc1 L_fw_38
L_fd_39:
    v_max3_f32 v28, v32, v33, v34
    v_max_f32 v28, v28, v35
    v_sub_f32 v16, v16, v28
    v_sub_f32 v17, v17, v28
    v_sub_f32 v18, v18, v28
    v_sub_f32 v19, v19, v28
    v_sub_f32 v20, v20, v28
    v_sub_f32 v21, v21, v28
    v_sub_f32 v22, v22, v28
    v_sub_f32 v23, v23, v28
    v_exp_f32 v16, v16
    v_exp_f32 v17, v17
    v_exp_f32 v18, v18
    v_exp_f32 v19, v19
    v_exp_f32 v20, v20
    v_exp_f32 v21, v21
    v_exp_f32 v22, v22
    v_exp_f32 v23, v23
    v_cvt_pk_bf16_f32 v32, v16, v17
    v_cvt_pk_bf16_f32 v33, v18, v19
    v_cvt_pk_bf16_f32 v34, v20, v21
    v_cvt_pk_bf16_f32 v35, v22, v23
    ds_write_b128 v6, v[32:35] offset:6160
    s_mov_b64 exec, 1
    ds_write_b32 v4, v3 offset:80
    s_mov_b64 exec, -1
L_fin:
L_end:
    s_endpgm
L_code_end:
.section .rodata,"a"
.p2align 6
.amdhsa_kernel recurrent_scan__compressed_kv_cla__geglu_ffn__decode_kernel
  .amdhsa_next_free_vgpr 256
  .amdhsa_next_free_sgpr 102
  .amdhsa_accum_offset 256
  .amdhsa_group_segment_fixed_size 0
  .amdhsa_kernarg_size 104
  .amdhsa_user_sgpr_count 2
  .amdhsa_user_sgpr_kernarg_segment_ptr 1
  .amdhsa_system_sgpr_workgroup_id_x 1
.end_amdhsa_kernel
```
